```python
import torch

def _softmax(x, axis=-1):
    return torch.softmax(x, dim=axis)
def _gelu(x):
    return torch.nn.functional.gelu(x, approximate="tanh")
def _silu(x):
    return torch.nn.functional.silu(x)
def _sigmoid(x):
    return torch.sigmoid(x)
def _layernorm(x, axis=-1, eps=1e-5):
    m = x.mean(dim=axis, keepdim=True)
    v = x.var(dim=axis, keepdim=True, unbiased=False)
    return (x - m) / torch.sqrt(v + eps)
def _scatter_add(tgt, idx, src, axis=0):
    return tgt.clone().index_add_(axis, idx, src)
def _segment_sum(src, seg, n):
    out = torch.zeros((n,) + src.shape[1:], dtype=src.dtype)
    return out.index_add_(0, seg, src)
def _pad(x, pw):
    flat = tuple(v for pair in reversed(pw) for v in pair)
    return torch.nn.functional.pad(x, flat)

kernel_name = 'standalone__modern_conv_block_convnext_v2__vision'

def setup_inputs():

    _w = (lambda a: (lambda t: t.to(torch.bfloat16) if t.is_floating_point() else t)(torch.as_tensor(a)))
    H = W = 224
    C = 96
    K = 7
    return {
        "x": _w((lambda *s: torch.randn(*s, dtype=torch.bfloat16) * 0.05)(1, H, W, C)),
        "dw": _w((lambda *s: torch.randn(*s, dtype=torch.bfloat16) * 0.05)(K, K, C)),
        "w1": _w((lambda *s: torch.randn(*s, dtype=torch.bfloat16) * 0.05)(C, 4 * C)),
        "w2": _w((lambda *s: torch.randn(*s, dtype=torch.bfloat16) * 0.05)(4 * C, C)),
        "grn_gamma": _w((lambda *s: torch.randn(*s, dtype=torch.bfloat16) * 0.05)(4 * C)),
        "grn_beta": _w((lambda *s: torch.randn(*s, dtype=torch.bfloat16) * 0.05)(4 * C)),
    }

def reference(x, dw, w1, w2, grn_gamma, grn_beta):
    B, H, W, C = x.shape
    K = dw.shape[0]
    pad = K // 2
    xp = _pad(x, ((0,0),(pad,pad),(pad,pad),(0,0)))
    out = torch.zeros_like(x)
    for i in range(K):
        for j in range(K):
            out = out + xp[:, i:i+H, j:j+W, :] * dw[i, j][None, None, None, :]
    h = _layernorm(out, axis=-1)
    h = torch.einsum('bhwc,ce->bhwe', h, w1)
    h = _gelu(h)
    gx = torch.sqrt((h * h).sum(axis=(1, 2), keepdims=True) + 1e-6)
    nx = gx / (gx.mean(axis=-1, keepdims=True) + 1e-6)
    h = grn_gamma * (h * nx) + grn_beta + h
    h = torch.einsum('bhwe,ec->bhwc', h, w2)
    return x + h
```

```asm
; @launch grid=(256,1,1) block=(768,1,1) lds=161536
.amdgcn_target "amdgcn-amd-amdhsa--gfx950"
.text
.globl standalone__modern_conv_block_convnext_v2__vision_kernel
.p2align 8
.type standalone__modern_conv_block_convnext_v2__vision_kernel,@function
standalone__modern_conv_block_convnext_v2__vision_kernel:
    s_cmp_ge_u32 s2, 256
    s_cbranch_scc1 L_end
    s_load_dwordx16 s[48:63], s[0:1], 0
    s_load_dwordx2 s[64:65], s[0:1], 64
    v_lshrrev_b32 v2, 6, v0
    v_and_b32 v1, 63, v0
    v_readfirstlane_b32 s40, v2
    s_and_b32 s43, s2, 7
    s_lshr_b32 s44, s2, 3
    s_lshr_b32 s45, s43, 1
    s_lshl_b32 s45, s45, 2
    s_lshr_b32 s46, s44, 3
    s_add_u32 s45, s45, s46
    s_mul_i32 s41, s45, 14
    s_and_b32 s45, s43, 1
    s_lshl_b32 s45, s45, 3
    s_and_b32 s46, s44, 7
    s_add_u32 s45, s45, s46
    s_mul_i32 s42, s45, 14
    s_mov_b32 s47, 0x80000000
    s_mov_b32 s66, 0x05040100
    s_mov_b32 s67, 0x07060302
    s_mov_b32 s68, 0
    s_mov_b32 s69, 12288
    s_mov_b32 s70, 24576
    s_mov_b32 s71, 36864
    s_mov_b32 s72, 49152
    s_mov_b32 s73, 61440
    s_cmp_ge_u32 s40, 6
    s_cselect_b32 s78, 1, 0
    s_mul_i32 s43, s78, 6
    s_sub_u32 s77, s40, s43
    s_lshl_b32 s79, s40, 10
    s_sub_u32 s43, s41, 3
    s_sub_u32 s44, s42, 3
    s_movk_i32 s45, 224
    s_movk_i32 s46, 192
    v_mov_b32 v10, s47
    v_mov_b32 v12, 1000
    v_add_u32 v3, 0, v0
    v_mul_u32_u24 v4, 43691, v3
    v_lshrrev_b32 v4, 19, v4
    v_mul_u32_u24 v6, 205, v4
    v_mul_u32_u24 v5, 12, v4
    v_lshrrev_b32 v6, 10, v6
    v_sub_u32 v5, v3, v5
    v_mul_u32_u24 v7, 5, v6
    v_sub_u32 v7, v4, v7
    v_add_u32 v9, s43, v6
    v_lshl_add_u32 v11, v7, 2, s44
    v_mad_i32_i24 v8, v9, s45, v11
    v_mul_i32_i24 v8, v8, s46
    v_lshl_add_u32 v8, v5, 4, v8
    v_cmp_gt_u32 vcc, s45, v9
    s_nop 1
    v_cndmask_b32 v11, v12, v11, vcc
    v_add_u32 v9, 0, v11
    v_cmp_gt_u32 vcc, s45, v9
    v_add_u32 v13, 0, v8
    s_nop 0
    v_cndmask_b32 v56, v10, v13, vcc
    v_add_u32 v9, 1, v11
    v_cmp_gt_u32 vcc, s45, v9
    v_add_u32 v13, 192, v8
    s_nop 0
    v_cndmask_b32 v57, v10, v13, vcc
    v_add_u32 v9, 2, v11
    v_cmp_gt_u32 vcc, s45, v9
    v_add_u32 v13, 384, v8
    s_nop 0
    v_cndmask_b32 v58, v10, v13, vcc
    v_add_u32 v9, 3, v11
    v_cmp_gt_u32 vcc, s45, v9
    v_add_u32 v13, 576, v8
    s_nop 0
    v_cndmask_b32 v59, v10, v13, vcc
    s_waitcnt lgkmcnt(0)
    s_mov_b32 s4, s48
    s_and_b32 s5, s49, 0xffff
    s_mov_b32 s6, 9633792
    s_mov_b32 s7, 0x00020000
    s_cmp_eq_u32 s40, 11
    s_cbranch_scc0 L_nz
    s_mov_b32 s36, s64
    s_and_b32 s37, s65, 0xffff
    s_mov_b32 s38, 394752
    s_mov_b32 s39, 0x00020000
    v_mov_b32 v68, 0
    v_mov_b32 v69, 0
    v_mov_b32 v70, 0
    v_mov_b32 v71, 0
    s_mul_i32 s76, s2, 1536
    v_lshlrev_b32 v72, 4, v1
    buffer_store_dwordx4 v[68:71], v72, s[36:39], s76 offen sc1
    s_lshl_b32 s74, s2, 4
    s_add_u32 s74, s74, 393216
    s_add_u32 s76, s76, 1024
    v_add_u32 v73, s76, v72
    v_mov_b32 v74, s74
    v_cmp_eq_u32 vcc, 32, v1
    s_nop 1
    v_cndmask_b32 v74, v10, v74, vcc
    v_cmp_gt_u32 vcc, 32, v1
    s_nop 1
    v_cndmask_b32 v73, v74, v73, vcc
    buffer_store_dwordx4 v[68:71], v73, s[36:39], 0 offen sc1
L_nz:
    buffer_load_dwordx4 v[16:19], v56, s[4:7], 0 offen
    buffer_load_dwordx4 v[20:23], v57, s[4:7], 0 offen
    buffer_load_dwordx4 v[24:27], v58, s[4:7], 0 offen
    buffer_load_dwordx4 v[28:31], v59, s[4:7], 0 offen
    v_mul_u32_u24 v8, 6480, v5
    v_mul_u32_u24 v9, 40, v6
    v_lshl_add_u32 v9, v7, 3, v9
    v_add_u32 v64, v8, v9
    s_cmp_ge_u32 s40, 7
    s_cbranch_scc1 L_x1a
    v_add_u32 v3, 768, v0
    v_mul_u32_u24 v4, 43691, v3
    v_lshrrev_b32 v4, 19, v4
    v_mul_u32_u24 v6, 205, v4
    v_mul_u32_u24 v5, 12, v4
    v_lshrrev_b32 v6, 10, v6
    v_sub_u32 v5, v3, v5
    v_mul_u32_u24 v7, 5, v6
    v_sub_u32 v7, v4, v7
    v_add_u32 v9, s43, v6
    v_lshl_add_u32 v11, v7, 2, s44
    v_mad_i32_i24 v8, v9, s45, v11
    v_mul_i32_i24 v8, v8, s46
    v_lshl_add_u32 v8, v5, 4, v8
    v_cmp_gt_u32 vcc, 1200, v3
    s_nop 1
    v_cndmask_b32 v11, v12, v11, vcc
    v_cmp_gt_u32 vcc, s45, v9
    s_nop 1
    v_cndmask_b32 v11, v12, v11, vcc
    v_add_u32 v9, 0, v11
    v_cmp_gt_u32 vcc, s45, v9
    v_add_u32 v13, 0, v8
    s_nop 0
    v_cndmask_b32 v60, v10, v13, vcc
    v_add_u32 v9, 1, v11
    v_cmp_gt_u32 vcc, s45, v9
    v_add_u32 v13, 192, v8
    s_nop 0
    v_cndmask_b32 v61, v10, v13, vcc
    v_add_u32 v9, 2, v11
    v_cmp_gt_u32 vcc, s45, v9
    v_add_u32 v13, 384, v8
    s_nop 0
    v_cndmask_b32 v62, v10, v13, vcc
    v_add_u32 v9, 3, v11
    v_cmp_gt_u32 vcc, s45, v9
    v_add_u32 v13, 576, v8
    s_nop 0
    v_cndmask_b32 v63, v10, v13, vcc
    buffer_load_dwordx4 v[32:35], v60, s[4:7], 0 offen
    buffer_load_dwordx4 v[36:39], v61, s[4:7], 0 offen
    buffer_load_dwordx4 v[40:43], v62, s[4:7], 0 offen
    buffer_load_dwordx4 v[44:47], v63, s[4:7], 0 offen
    v_mul_u32_u24 v8, 6480, v5
    v_mul_u32_u24 v9, 40, v6
    v_lshl_add_u32 v9, v7, 3, v9
    v_add_u32 v65, v8, v9
L_x1a:
    s_mov_b32 s8, s50
    s_and_b32 s9, s51, 0xffff
    s_mov_b32 s10, 9408
    s_mov_b32 s11, 0x00020000
    s_mov_b32 s24, s58
    s_and_b32 s25, s59, 0xffff
    s_mov_b32 s26, 768
    s_mov_b32 s27, 0x00020000
    s_cmp_eq_u32 s40, 11
    s_cbranch_scc0 L_nb
    v_lshlrev_b32 v7, 4, v1
    buffer_load_dwordx4 v[12:15], v7, s[24:27], 0 offen
    s_branch L_nb2
L_nb:
    v_mul_u32_u24 v3, 683, v0
    v_lshrrev_b32 v3, 16, v3
    v_mul_u32_u24 v4, 96, v3
    v_sub_u32 v4, v0, v4
    v_mul_u32_u24 v5, 1344, v3
    v_lshl_add_u32 v5, v4, 1, v5
    buffer_load_ushort v48, v5, s[8:11], 0 offen offset:0
    buffer_load_ushort v49, v5, s[8:11], 0 offen offset:192
    buffer_load_ushort v50, v5, s[8:11], 0 offen offset:384
    buffer_load_ushort v51, v5, s[8:11], 0 offen offset:576
    buffer_load_ushort v52, v5, s[8:11], 0 offen offset:768
    buffer_load_ushort v53, v5, s[8:11], 0 offen offset:960
    buffer_load_ushort v54, v5, s[8:11], 0 offen offset:1152
    v_mul_u32_u24 v6, 7, v4
    v_add_u32 v6, v6, v3
    v_mul_u32_u24 v6, 48, v6
    v_add_u32 v66, 77888, v6
L_nb2:
    s_mov_b32 s36, s64
    s_and_b32 s37, s65, 0xffff
    s_mov_b32 s38, 394752
    s_mov_b32 s39, 0x00020000
    s_mov_b32 s12, s52
    s_and_b32 s13, s53, 0xffff
    s_mov_b32 s14, 73728
    s_mov_b32 s15, 0x00020000
    s_mov_b32 s16, s54
    s_and_b32 s17, s55, 0xffff
    s_mov_b32 s18, 73728
    s_mov_b32 s19, 0x00020000
    s_mov_b32 s20, s56
    s_and_b32 s21, s57, 0xffff
    s_mov_b32 s22, 768
    s_mov_b32 s23, 0x00020000
    s_mov_b32 s28, s60
    s_and_b32 s29, s61, 0xffff
    s_mov_b32 s30, 9633792
    s_mov_b32 s31, 0x00020000
    s_mov_b32 s32, s62
    s_and_b32 s33, s63, 0xffff
    s_mov_b32 s34, 256
    s_mov_b32 s35, 0x00020000
    s_cmp_ge_u32 s40, 7
    s_cbranch_scc1 L_w7
    s_waitcnt vmcnt(11)
    s_branch L_w0
L_w7:
    s_cmp_eq_u32 s40, 11
    s_cbranch_scc1 L_w11
    s_waitcnt vmcnt(7)
    s_branch L_w0
L_w11:
    s_waitcnt vmcnt(0)
L_w0:
    v_perm_b32 v80, v20, v16, s66
    v_perm_b32 v81, v28, v24, s66
    v_perm_b32 v82, v20, v16, s67
    v_perm_b32 v83, v28, v24, s67
    v_perm_b32 v84, v21, v17, s66
    v_perm_b32 v85, v29, v25, s66
    v_perm_b32 v86, v21, v17, s67
    v_perm_b32 v87, v29, v25, s67
    v_perm_b32 v88, v22, v18, s66
    v_perm_b32 v89, v30, v26, s66
    v_perm_b32 v90, v22, v18, s67
    v_perm_b32 v91, v30, v26, s67
    v_perm_b32 v92, v23, v19, s66
    v_perm_b32 v93, v31, v27, s66
    v_perm_b32 v94, v23, v19, s67
    v_perm_b32 v95, v31, v27, s67
    ds_write_b64 v64, v[80:81] offset:0
    ds_write_b64 v64, v[82:83] offset:808
    ds_write_b64 v64, v[84:85] offset:1616
    ds_write_b64 v64, v[86:87] offset:2424
    ds_write_b64 v64, v[88:89] offset:3232
    ds_write_b64 v64, v[90:91] offset:4040
    ds_write_b64 v64, v[92:93] offset:4848
    ds_write_b64 v64, v[94:95] offset:5656
    s_cmp_ge_u32 s40, 7
    s_cbranch_scc1 L_x1skip
    v_cmp_gt_u32 vcc, 432, v0
    s_and_saveexec_b64 s[74:75], vcc
    s_waitcnt vmcnt(7)
    v_perm_b32 v96, v36, v32, s66
    v_perm_b32 v97, v44, v40, s66
    v_perm_b32 v98, v36, v32, s67
    v_perm_b32 v99, v44, v40, s67
    v_perm_b32 v100, v37, v33, s66
    v_perm_b32 v101, v45, v41, s66
    v_perm_b32 v102, v37, v33, s67
    v_perm_b32 v103, v45, v41, s67
    v_perm_b32 v104, v38, v34, s66
    v_perm_b32 v105, v46, v42, s66
    v_perm_b32 v106, v38, v34, s67
    v_perm_b32 v107, v46, v42, s67
    v_perm_b32 v108, v39, v35, s66
    v_perm_b32 v109, v47, v43, s66
    v_perm_b32 v110, v39, v35, s67
    v_perm_b32 v111, v47, v43, s67
    ds_write_b64 v65, v[96:97] offset:0
    ds_write_b64 v65, v[98:99] offset:808
    ds_write_b64 v65, v[100:101] offset:1616
    ds_write_b64 v65, v[102:103] offset:2424
    ds_write_b64 v65, v[104:105] offset:3232
    ds_write_b64 v65, v[106:107] offset:4040
    ds_write_b64 v65, v[108:109] offset:4848
    ds_write_b64 v65, v[110:111] offset:5656
    s_mov_b64 exec, s[74:75]
L_x1skip:
    s_waitcnt vmcnt(0)
    s_cmp_eq_u32 s40, 11
    s_cbranch_scc1 L_beta
    v_mov_b32 v68, 0
    v_lshl_or_b32 v69, v49, 16, v48
    v_lshl_or_b32 v70, v51, 16, v50
    v_lshl_or_b32 v71, v53, 16, v52
    v_mov_b32 v72, v54
    v_mov_b32 v73, 0
    v_mov_b32 v74, 0
    v_lshlrev_b32 v75, 16, v48
    v_lshl_or_b32 v76, v50, 16, v49
    v_lshl_or_b32 v77, v52, 16, v51
    v_lshl_or_b32 v78, v54, 16, v53
    v_mov_b32 v79, 0
    v_cmp_gt_u32 vcc, 673, v0
    s_and_saveexec_b64 s[74:75], vcc
    v_mov_b32 v7, 110144
    v_cmp_eq_u32 vcc, 672, v0
    s_nop 1
    v_cndmask_b32 v66, v66, v7, vcc
    ds_write_b128 v66, v[68:71]
    ds_write_b128 v66, v[72:75] offset:16
    ds_write_b128 v66, v[76:79] offset:32
    s_mov_b64 exec, s[74:75]
    s_branch L_xw
L_beta:
    v_cmp_gt_u32 vcc, 48, v1
    s_and_saveexec_b64 s[74:75], vcc
    v_add_u32 v7, 159744, v7
    ds_write_b128 v7, v[12:15]
    s_mov_b64 exec, s[74:75]
    v_mov_b32 v9, 0
    v_mov_b32 v8, 1
    s_mov_b64 exec, 1
    buffer_atomic_add v8, v9, s[32:35], 0 offen
    s_mov_b64 exec, -1
L_xw:
    v_lshrrev_b32 v2, 2, v1
    v_and_b32 v3, 3, v1
    s_lshl_b32 s43, s77, 4
    v_add_u32 v4, s43, v2
    v_mul_u32_u24 v5, 336, v4
    v_and_b32 v6, 1, v3
    v_mul_u32_u24 v6, 24, v6
    v_lshrrev_b32 v7, 1, v3
    v_xor_b32 v7, 1, v7
    v_lshl_add_u32 v6, v7, 2, v6
    v_add_u32 v6, 77888, v6
    v_add_u32 v5, v5, v6
    v_lshrrev_b32 v6, 3, v4
    v_mul_u32_u24 v6, 6480, v6
    v_and_b32 v7, 7, v4
    v_mul_u32_u24 v7, 808, v7
    v_add_u32 v6, v6, v7
    v_mul_u32_u24 v7, 160, v3
    s_mul_i32 s44, s78, 80
    v_add3_u32 v6, v6, v7, s44
    v_mul_u32_u24 v7, 22496, v3
    v_lshl_add_u32 v7, v4, 2, v7
    s_mul_i32 s44, s78, 11232
    s_add_u32 s44, s44, 77888
    v_add_u32 v7, s44, v7
    s_lshl_b32 s44, s78, 2
    v_add_u32 v9, s44, v3
    v_mov_b32 v10, 78272
    v_cmp_eq_u32 vcc, 7, v9
    s_nop 1
    v_cndmask_b32 v7, v7, v10, vcc
    v_mul_u32_u24 v8, 1366, v0
    v_lshrrev_b32 v8, 16, v8
    v_mul_u32_u24 v9, 48, v8
    v_sub_u32 v9, v0, v9
    v_and_b32 v10, 3, v8
    v_bfe_u32 v11, v8, 3, 1
    v_lshl_or_b32 v10, v11, 2, v10
    v_lshlrev_b32 v10, 1, v10
    v_xor_b32 v9, v9, v10
    v_mul_u32_u24 v8, 768, v8
    v_lshl_add_u32 v8, v9, 4, v8
    s_waitcnt lgkmcnt(0)
    s_barrier
    ds_read_b64 v[58:59], v6 offset:0
    ds_read_b64 v[60:61], v6 offset:8
    ds_read_b64 v[62:63], v6 offset:16
    ds_read_b64 v[64:65], v6 offset:24
    ds_read_b64 v[66:67], v6 offset:32
    ds_read2_b32 v[16:17], v5 offset0:0 offset1:1
    ds_read2_b32 v[18:19], v5 offset0:2 offset1:3
    ds_read2_b32 v[20:21], v5 offset0:4 offset1:5
    ds_read2_b32 v[22:23], v5 offset0:12 offset1:13
    ds_read2_b32 v[24:25], v5 offset0:14 offset1:15
    ds_read2_b32 v[26:27], v5 offset0:16 offset1:17
    ds_read2_b32 v[28:29], v5 offset0:24 offset1:25
    ds_read2_b32 v[30:31], v5 offset0:26 offset1:27
    ds_read2_b32 v[32:33], v5 offset0:28 offset1:29
    ds_read2_b32 v[34:35], v5 offset0:36 offset1:37
    ds_read2_b32 v[36:37], v5 offset0:38 offset1:39
    ds_read2_b32 v[38:39], v5 offset0:40 offset1:41
    ds_read2_b32 v[40:41], v5 offset0:48 offset1:49
    ds_read2_b32 v[42:43], v5 offset0:50 offset1:51
    ds_read2_b32 v[44:45], v5 offset0:52 offset1:53
    ds_read2_b32 v[46:47], v5 offset0:60 offset1:61
    ds_read2_b32 v[48:49], v5 offset0:62 offset1:63
    ds_read2_b32 v[50:51], v5 offset0:64 offset1:65
    ds_read2_b32 v[52:53], v5 offset0:72 offset1:73
    ds_read2_b32 v[54:55], v5 offset0:74 offset1:75
    ds_read2_b32 v[56:57], v5 offset0:76 offset1:77
    s_cmp_ge_u32 s40, 6
    s_cbranch_scc1 L_npf
    s_lshr_b32 s43, s2, 3
    s_mul_i32 s43, s43, 2304
    v_lshlrev_b32 v9, 4, v0
    s_cmp_ge_u32 s40, 3
    s_cbranch_scc1 L_pf2
    buffer_load_dwordx4 v[112:115], v9, s[12:15], s43 offen
    s_branch L_npf
L_pf2:
    v_subrev_u32 v9, 3072, v9
    buffer_load_dwordx4 v[112:115], v9, s[16:19], s43 offen
L_npf:
    ds_read_b64 v[68:69], v6 offset:40
    ds_read_b64 v[70:71], v6 offset:48
    ds_read_b64 v[72:73], v6 offset:56
    ds_read_b64 v[74:75], v6 offset:64
    ds_read_b64 v[76:77], v6 offset:72
    s_waitcnt lgkmcnt(5)
    v_mfma_f32_4x4x4_16b_bf16 v[80:83], v[16:17], v[58:59], 0
    v_mfma_f32_4x4x4_16b_bf16 v[84:87], v[16:17], v[60:61], 0
    v_mfma_f32_4x4x4_16b_bf16 v[88:91], v[16:17], v[62:63], 0
    v_mfma_f32_4x4x4_16b_bf16 v[92:95], v[16:17], v[64:65], 0
    v_mfma_f32_4x4x4_16b_bf16 v[80:83], v[18:19], v[60:61], v[80:83]
    v_mfma_f32_4x4x4_16b_bf16 v[84:87], v[18:19], v[62:63], v[84:87]
    v_mfma_f32_4x4x4_16b_bf16 v[88:91], v[18:19], v[64:65], v[88:91]
    v_mfma_f32_4x4x4_16b_bf16 v[92:95], v[18:19], v[66:67], v[92:95]
    v_mfma_f32_4x4x4_16b_bf16 v[80:83], v[20:21], v[62:63], v[80:83]
    v_mfma_f32_4x4x4_16b_bf16 v[84:87], v[20:21], v[64:65], v[84:87]
    v_mfma_f32_4x4x4_16b_bf16 v[88:91], v[20:21], v[66:67], v[88:91]
    ds_read_b64 v[58:59], v6 offset:80
    ds_read_b64 v[60:61], v6 offset:88
    ds_read_b64 v[62:63], v6 offset:96
    ds_read_b64 v[64:65], v6 offset:104
    ds_read_b64 v[66:67], v6 offset:112
    s_waitcnt lgkmcnt(5)
    v_mfma_f32_4x4x4_16b_bf16 v[80:83], v[22:23], v[68:69], v[80:83]
    v_mfma_f32_4x4x4_16b_bf16 v[84:87], v[22:23], v[70:71], v[84:87]
    v_mfma_f32_4x4x4_16b_bf16 v[88:91], v[22:23], v[72:73], v[88:91]
    v_mfma_f32_4x4x4_16b_bf16 v[92:95], v[22:23], v[74:75], v[92:95]
    v_mfma_f32_4x4x4_16b_bf16 v[96:99], v[16:17], v[68:69], 0
    v_mfma_f32_4x4x4_16b_bf16 v[100:103], v[16:17], v[70:71], 0
    v_mfma_f32_4x4x4_16b_bf16 v[104:107], v[16:17], v[72:73], 0
    v_mfma_f32_4x4x4_16b_bf16 v[108:111], v[16:17], v[74:75], 0
    v_mfma_f32_4x4x4_16b_bf16 v[80:83], v[24:25], v[70:71], v[80:83]
    v_mfma_f32_4x4x4_16b_bf16 v[84:87], v[24:25], v[72:73], v[84:87]
    v_mfma_f32_4x4x4_16b_bf16 v[88:91], v[24:25], v[74:75], v[88:91]
    v_mfma_f32_4x4x4_16b_bf16 v[92:95], v[24:25], v[76:77], v[92:95]
    v_mfma_f32_4x4x4_16b_bf16 v[96:99], v[18:19], v[70:71], v[96:99]
    v_mfma_f32_4x4x4_16b_bf16 v[100:103], v[18:19], v[72:73], v[100:103]
    v_mfma_f32_4x4x4_16b_bf16 v[104:107], v[18:19], v[74:75], v[104:107]
    v_mfma_f32_4x4x4_16b_bf16 v[108:111], v[18:19], v[76:77], v[108:111]
    v_mfma_f32_4x4x4_16b_bf16 v[80:83], v[26:27], v[72:73], v[80:83]
    v_mfma_f32_4x4x4_16b_bf16 v[84:87], v[26:27], v[74:75], v[84:87]
    v_mfma_f32_4x4x4_16b_bf16 v[88:91], v[26:27], v[76:77], v[88:91]
    v_mfma_f32_4x4x4_16b_bf16 v[96:99], v[20:21], v[72:73], v[96:99]
    v_mfma_f32_4x4x4_16b_bf16 v[100:103], v[20:21], v[74:75], v[100:103]
    v_mfma_f32_4x4x4_16b_bf16 v[104:107], v[20:21], v[76:77], v[104:107]
    ds_read_b64 v[68:69], v6 offset:120
    ds_read_b64 v[70:71], v6 offset:128
    ds_read_b64 v[72:73], v6 offset:136
    ds_read_b64 v[74:75], v6 offset:144
    ds_read_b64 v[76:77], v6 offset:152
    s_waitcnt lgkmcnt(5)
    v_mfma_f32_4x4x4_16b_bf16 v[80:83], v[28:29], v[58:59], v[80:83]
    v_mfma_f32_4x4x4_16b_bf16 v[84:87], v[28:29], v[60:61], v[84:87]
    v_mfma_f32_4x4x4_16b_bf16 v[88:91], v[28:29], v[62:63], v[88:91]
    v_mfma_f32_4x4x4_16b_bf16 v[92:95], v[28:29], v[64:65], v[92:95]
    v_mfma_f32_4x4x4_16b_bf16 v[96:99], v[22:23], v[58:59], v[96:99]
    v_mfma_f32_4x4x4_16b_bf16 v[100:103], v[22:23], v[60:61], v[100:103]
    v_mfma_f32_4x4x4_16b_bf16 v[104:107], v[22:23], v[62:63], v[104:107]
    v_mfma_f32_4x4x4_16b_bf16 v[108:111], v[22:23], v[64:65], v[108:111]
    v_mfma_f32_4x4x4_16b_bf16 v[80:83], v[30:31], v[60:61], v[80:83]
    v_mfma_f32_4x4x4_16b_bf16 v[84:87], v[30:31], v[62:63], v[84:87]
    v_mfma_f32_4x4x4_16b_bf16 v[88:91], v[30:31], v[64:65], v[88:91]
    v_mfma_f32_4x4x4_16b_bf16 v[92:95], v[30:31], v[66:67], v[92:95]
    v_mfma_f32_4x4x4_16b_bf16 v[96:99], v[24:25], v[60:61], v[96:99]
    v_mfma_f32_4x4x4_16b_bf16 v[100:103], v[24:25], v[62:63], v[100:103]
    v_mfma_f32_4x4x4_16b_bf16 v[104:107], v[24:25], v[64:65], v[104:107]
    v_mfma_f32_4x4x4_16b_bf16 v[108:111], v[24:25], v[66:67], v[108:111]
    v_mfma_f32_4x4x4_16b_bf16 v[80:83], v[32:33], v[62:63], v[80:83]
    v_mfma_f32_4x4x4_16b_bf16 v[84:87], v[32:33], v[64:65], v[84:87]
    v_mfma_f32_4x4x4_16b_bf16 v[88:91], v[32:33], v[66:67], v[88:91]
    v_mfma_f32_4x4x4_16b_bf16 v[96:99], v[26:27], v[62:63], v[96:99]
    v_mfma_f32_4x4x4_16b_bf16 v[100:103], v[26:27], v[64:65], v[100:103]
    v_mfma_f32_4x4x4_16b_bf16 v[104:107], v[26:27], v[66:67], v[104:107]
    ds_read_b64 v[58:59], v6 offset:160
    ds_read_b64 v[60:61], v6 offset:168
    ds_read_b64 v[62:63], v6 offset:176
    ds_read_b64 v[64:65], v6 offset:184
    ds_read_b64 v[66:67], v6 offset:192
    s_waitcnt lgkmcnt(5)
    v_mfma_f32_4x4x4_16b_bf16 v[80:83], v[34:35], v[68:69], v[80:83]
    v_mfma_f32_4x4x4_16b_bf16 v[84:87], v[34:35], v[70:71], v[84:87]
    v_mfma_f32_4x4x4_16b_bf16 v[88:91], v[34:35], v[72:73], v[88:91]
    v_mfma_f32_4x4x4_16b_bf16 v[92:95], v[34:35], v[74:75], v[92:95]
    v_mfma_f32_4x4x4_16b_bf16 v[96:99], v[28:29], v[68:69], v[96:99]
    v_mfma_f32_4x4x4_16b_bf16 v[100:103], v[28:29], v[70:71], v[100:103]
    v_mfma_f32_4x4x4_16b_bf16 v[104:107], v[28:29], v[72:73], v[104:107]
    v_mfma_f32_4x4x4_16b_bf16 v[108:111], v[28:29], v[74:75], v[108:111]
    v_mfma_f32_4x4x4_16b_bf16 v[80:83], v[36:37], v[70:71], v[80:83]
    v_mfma_f32_4x4x4_16b_bf16 v[84:87], v[36:37], v[72:73], v[84:87]
    v_mfma_f32_4x4x4_16b_bf16 v[88:91], v[36:37], v[74:75], v[88:91]
    v_mfma_f32_4x4x4_16b_bf16 v[92:95], v[36:37], v[76:77], v[92:95]
    v_mfma_f32_4x4x4_16b_bf16 v[96:99], v[30:31], v[70:71], v[96:99]
    v_mfma_f32_4x4x4_16b_bf16 v[100:103], v[30:31], v[72:73], v[100:103]
    v_mfma_f32_4x4x4_16b_bf16 v[104:107], v[30:31], v[74:75], v[104:107]
    v_mfma_f32_4x4x4_16b_bf16 v[108:111], v[30:31], v[76:77], v[108:111]
    v_mfma_f32_4x4x4_16b_bf16 v[80:83], v[38:39], v[72:73], v[80:83]
    v_mfma_f32_4x4x4_16b_bf16 v[84:87], v[38:39], v[74:75], v[84:87]
    v_mfma_f32_4x4x4_16b_bf16 v[88:91], v[38:39], v[76:77], v[88:91]
    v_mfma_f32_4x4x4_16b_bf16 v[96:99], v[32:33], v[72:73], v[96:99]
    v_mfma_f32_4x4x4_16b_bf16 v[100:103], v[32:33], v[74:75], v[100:103]
    v_mfma_f32_4x4x4_16b_bf16 v[104:107], v[32:33], v[76:77], v[104:107]
    ds_read_b64 v[68:69], v6 offset:200
    ds_read_b64 v[70:71], v6 offset:208
    ds_read_b64 v[72:73], v6 offset:216
    ds_read_b64 v[74:75], v6 offset:224
    ds_read_b64 v[76:77], v6 offset:232
    s_waitcnt lgkmcnt(5)
    v_mfma_f32_4x4x4_16b_bf16 v[80:83], v[40:41], v[58:59], v[80:83]
    v_mfma_f32_4x4x4_16b_bf16 v[84:87], v[40:41], v[60:61], v[84:87]
    v_mfma_f32_4x4x4_16b_bf16 v[88:91], v[40:41], v[62:63], v[88:91]
    v_mfma_f32_4x4x4_16b_bf16 v[92:95], v[40:41], v[64:65], v[92:95]
    v_mfma_f32_4x4x4_16b_bf16 v[96:99], v[34:35], v[58:59], v[96:99]
    v_mfma_f32_4x4x4_16b_bf16 v[100:103], v[34:35], v[60:61], v[100:103]
    v_mfma_f32_4x4x4_16b_bf16 v[104:107], v[34:35], v[62:63], v[104:107]
    v_mfma_f32_4x4x4_16b_bf16 v[108:111], v[34:35], v[64:65], v[108:111]
    v_mfma_f32_4x4x4_16b_bf16 v[80:83], v[42:43], v[60:61], v[80:83]
    v_mfma_f32_4x4x4_16b_bf16 v[84:87], v[42:43], v[62:63], v[84:87]
    v_mfma_f32_4x4x4_16b_bf16 v[88:91], v[42:43], v[64:65], v[88:91]
    v_mfma_f32_4x4x4_16b_bf16 v[92:95], v[42:43], v[66:67], v[92:95]
    v_mfma_f32_4x4x4_16b_bf16 v[96:99], v[36:37], v[60:61], v[96:99]
    v_mfma_f32_4x4x4_16b_bf16 v[100:103], v[36:37], v[62:63], v[100:103]
    v_mfma_f32_4x4x4_16b_bf16 v[104:107], v[36:37], v[64:65], v[104:107]
    v_mfma_f32_4x4x4_16b_bf16 v[108:111], v[36:37], v[66:67], v[108:111]
    v_mfma_f32_4x4x4_16b_bf16 v[80:83], v[44:45], v[62:63], v[80:83]
    v_mfma_f32_4x4x4_16b_bf16 v[84:87], v[44:45], v[64:65], v[84:87]
    v_mfma_f32_4x4x4_16b_bf16 v[88:91], v[44:45], v[66:67], v[88:91]
    v_mfma_f32_4x4x4_16b_bf16 v[96:99], v[38:39], v[62:63], v[96:99]
    v_mfma_f32_4x4x4_16b_bf16 v[100:103], v[38:39], v[64:65], v[100:103]
    v_mfma_f32_4x4x4_16b_bf16 v[104:107], v[38:39], v[66:67], v[104:107]
    ds_read_b64 v[58:59], v6 offset:240
    ds_read_b64 v[60:61], v6 offset:248
    ds_read_b64 v[62:63], v6 offset:256
    ds_read_b64 v[64:65], v6 offset:264
    ds_read_b64 v[66:67], v6 offset:272
    s_waitcnt lgkmcnt(5)
    v_mfma_f32_4x4x4_16b_bf16 v[80:83], v[46:47], v[68:69], v[80:83]
    v_mfma_f32_4x4x4_16b_bf16 v[84:87], v[46:47], v[70:71], v[84:87]
    v_mfma_f32_4x4x4_16b_bf16 v[88:91], v[46:47], v[72:73], v[88:91]
    v_mfma_f32_4x4x4_16b_bf16 v[92:95], v[46:47], v[74:75], v[92:95]
    v_mfma_f32_4x4x4_16b_bf16 v[96:99], v[40:41], v[68:69], v[96:99]
    v_mfma_f32_4x4x4_16b_bf16 v[100:103], v[40:41], v[70:71], v[100:103]
    v_mfma_f32_4x4x4_16b_bf16 v[104:107], v[40:41], v[72:73], v[104:107]
    v_mfma_f32_4x4x4_16b_bf16 v[108:111], v[40:41], v[74:75], v[108:111]
    v_mfma_f32_4x4x4_16b_bf16 v[80:83], v[48:49], v[70:71], v[80:83]
    v_mfma_f32_4x4x4_16b_bf16 v[84:87], v[48:49], v[72:73], v[84:87]
    v_mfma_f32_4x4x4_16b_bf16 v[88:91], v[48:49], v[74:75], v[88:91]
    v_mfma_f32_4x4x4_16b_bf16 v[92:95], v[48:49], v[76:77], v[92:95]
    v_mfma_f32_4x4x4_16b_bf16 v[96:99], v[42:43], v[70:71], v[96:99]
    v_mfma_f32_4x4x4_16b_bf16 v[100:103], v[42:43], v[72:73], v[100:103]
    v_mfma_f32_4x4x4_16b_bf16 v[104:107], v[42:43], v[74:75], v[104:107]
    v_mfma_f32_4x4x4_16b_bf16 v[108:111], v[42:43], v[76:77], v[108:111]
    v_mfma_f32_4x4x4_16b_bf16 v[80:83], v[50:51], v[72:73], v[80:83]
    v_mfma_f32_4x4x4_16b_bf16 v[84:87], v[50:51], v[74:75], v[84:87]
    v_mfma_f32_4x4x4_16b_bf16 v[88:91], v[50:51], v[76:77], v[88:91]
    v_mfma_f32_4x4x4_16b_bf16 v[96:99], v[44:45], v[72:73], v[96:99]
    v_mfma_f32_4x4x4_16b_bf16 v[100:103], v[44:45], v[74:75], v[100:103]
    v_mfma_f32_4x4x4_16b_bf16 v[104:107], v[44:45], v[76:77], v[104:107]
    ds_read_b64 v[68:69], v6 offset:280
    ds_read_b64 v[70:71], v6 offset:288
    ds_read_b64 v[72:73], v6 offset:296
    ds_read_b64 v[74:75], v6 offset:304
    ds_read_b64 v[76:77], v6 offset:312
    s_waitcnt lgkmcnt(5)
    v_mfma_f32_4x4x4_16b_bf16 v[80:83], v[52:53], v[58:59], v[80:83]
    v_mfma_f32_4x4x4_16b_bf16 v[84:87], v[52:53], v[60:61], v[84:87]
    v_mfma_f32_4x4x4_16b_bf16 v[88:91], v[52:53], v[62:63], v[88:91]
    v_mfma_f32_4x4x4_16b_bf16 v[92:95], v[52:53], v[64:65], v[92:95]
    v_mfma_f32_4x4x4_16b_bf16 v[96:99], v[46:47], v[58:59], v[96:99]
    v_mfma_f32_4x4x4_16b_bf16 v[100:103], v[46:47], v[60:61], v[100:103]
    v_mfma_f32_4x4x4_16b_bf16 v[104:107], v[46:47], v[62:63], v[104:107]
    v_mfma_f32_4x4x4_16b_bf16 v[108:111], v[46:47], v[64:65], v[108:111]
    v_mfma_f32_4x4x4_16b_bf16 v[80:83], v[54:55], v[60:61], v[80:83]
    v_mfma_f32_4x4x4_16b_bf16 v[84:87], v[54:55], v[62:63], v[84:87]
    v_mfma_f32_4x4x4_16b_bf16 v[88:91], v[54:55], v[64:65], v[88:91]
    v_mfma_f32_4x4x4_16b_bf16 v[92:95], v[54:55], v[66:67], v[92:95]
    v_mfma_f32_4x4x4_16b_bf16 v[96:99], v[48:49], v[60:61], v[96:99]
    v_mfma_f32_4x4x4_16b_bf16 v[100:103], v[48:49], v[62:63], v[100:103]
    v_mfma_f32_4x4x4_16b_bf16 v[104:107], v[48:49], v[64:65], v[104:107]
    v_mfma_f32_4x4x4_16b_bf16 v[108:111], v[48:49], v[66:67], v[108:111]
    v_mfma_f32_4x4x4_16b_bf16 v[80:83], v[56:57], v[62:63], v[80:83]
    v_mfma_f32_4x4x4_16b_bf16 v[84:87], v[56:57], v[64:65], v[84:87]
    v_mfma_f32_4x4x4_16b_bf16 v[88:91], v[56:57], v[66:67], v[88:91]
    v_mfma_f32_4x4x4_16b_bf16 v[96:99], v[50:51], v[62:63], v[96:99]
    v_mfma_f32_4x4x4_16b_bf16 v[100:103], v[50:51], v[64:65], v[100:103]
    v_mfma_f32_4x4x4_16b_bf16 v[104:107], v[50:51], v[66:67], v[104:107]
    s_waitcnt lgkmcnt(0)
    v_mfma_f32_4x4x4_16b_bf16 v[96:99], v[52:53], v[68:69], v[96:99]
    v_mfma_f32_4x4x4_16b_bf16 v[100:103], v[52:53], v[70:71], v[100:103]
    v_mfma_f32_4x4x4_16b_bf16 v[104:107], v[52:53], v[72:73], v[104:107]
    v_mfma_f32_4x4x4_16b_bf16 v[108:111], v[52:53], v[74:75], v[108:111]
    v_mfma_f32_4x4x4_16b_bf16 v[96:99], v[54:55], v[70:71], v[96:99]
    v_mfma_f32_4x4x4_16b_bf16 v[100:103], v[54:55], v[72:73], v[100:103]
    v_mfma_f32_4x4x4_16b_bf16 v[104:107], v[54:55], v[74:75], v[104:107]
    v_mfma_f32_4x4x4_16b_bf16 v[108:111], v[54:55], v[76:77], v[108:111]
    v_mfma_f32_4x4x4_16b_bf16 v[96:99], v[56:57], v[72:73], v[96:99]
    v_mfma_f32_4x4x4_16b_bf16 v[100:103], v[56:57], v[74:75], v[100:103]
    v_mfma_f32_4x4x4_16b_bf16 v[104:107], v[56:57], v[76:77], v[104:107]
    s_barrier
    ds_write_b32 v7, v80 offset:0
    v_and_b32 v2, 15, v1
    v_lshrrev_b32 v3, 4, v1
    v_lshlrev_b32 v4, 4, v1
    ds_write_b32 v7, v81 offset:400
    s_lshl_b32 s43, s40, 4
    v_add_u32 v5, s43, v2
    v_mul_u32_u24 v10, 4682, v5
    ds_write_b32 v7, v82 offset:800
    v_lshrrev_b32 v10, 16, v10
    v_mul_u32_u24 v11, 14, v10
    v_sub_u32 v11, v5, v11
    ds_write_b32 v7, v83 offset:1200
    s_add_u32 m0, s79, s68
    s_nop 0
    buffer_load_dwordx4 v8, s[12:15], s68 offen lds
    v_lshrrev_b32 v5, 2, v10
    v_mul_u32_u24 v5, 32, v5
    v_mul_u32_u24 v10, 5616, v10
    ds_write_b32 v7, v84 offset:1600
    v_add_u32 v10, v10, v5
    v_mul_u32_u24 v11, 400, v11
    v_add_u32 v10, 77888, v10
    ds_write_b32 v7, v85 offset:2000
    v_lshl_add_u32 v11, v3, 5, v11
    v_add_u32 v5, v10, v11
    v_mov_b32 v12, 0xbc2aaaab
    ds_write_b32 v7, v86 offset:2400
    v_mov_b32 v13, 0x4091afa4
    v_mov_b32 v14, 0x383ef424
    ds_write_b32 v7, v87 offset:2800
    s_add_u32 m0, s79, s69
    s_nop 0
    buffer_load_dwordx4 v8, s[12:15], s69 offen lds
    s_mul_i32 s44, s41, 224
    s_add_u32 s44, s44, s42
    s_mul_i32 s44, s44, 192
    ds_write_b32 v7, v88 offset:3200
    s_lshl_b32 s45, s77, 5
    s_add_u32 s44, s44, s45
    v_lshl_add_u32 v15, v3, 3, s44
    ds_write_b32 v7, v89 offset:3600
    s_mul_i32 s45, s78, 112
    s_movk_i32 s44, 210
    s_movk_i32 s46, 192
    ds_write_b32 v7, v90 offset:4000
    v_add_u32 v6, s45, v2
    v_mul_u32_u24 v9, 4682, v6
    v_lshrrev_b32 v9, 16, v9
    ds_write_b32 v7, v91 offset:4400
    s_add_u32 m0, s79, s70
    s_nop 0
    buffer_load_dwordx4 v8, s[12:15], s70 offen lds
    v_mad_u32_u24 v9, v9, s44, v6
    v_mad_u32_u24 v156, v9, s46, v15
    v_add_u32 v6, 16, v6
    ds_write_b32 v7, v92 offset:4800
    v_mul_u32_u24 v9, 4682, v6
    v_lshrrev_b32 v9, 16, v9
    v_mad_u32_u24 v9, v9, s44, v6
    ds_write_b32 v7, v93 offset:5200
    v_mad_u32_u24 v157, v9, s46, v15
    v_add_u32 v6, 16, v6
    v_mul_u32_u24 v9, 4682, v6
    ds_write_b32 v7, v96 offset:5616
    v_lshrrev_b32 v9, 16, v9
    v_mad_u32_u24 v9, v9, s44, v6
    v_mad_u32_u24 v158, v9, s46, v15
    ds_write_b32 v7, v97 offset:6016
    s_add_u32 m0, s79, s71
    s_nop 0
    buffer_load_dwordx4 v8, s[12:15], s71 offen lds
    v_add_u32 v6, 16, v6
    v_mul_u32_u24 v9, 4682, v6
    v_lshrrev_b32 v9, 16, v9
    ds_write_b32 v7, v98 offset:6416
    v_mad_u32_u24 v9, v9, s44, v6
    v_mad_u32_u24 v159, v9, s46, v15
    v_add_u32 v6, 16, v6
    ds_write_b32 v7, v99 offset:6816
    v_mul_u32_u24 v9, 4682, v6
    v_lshrrev_b32 v9, 16, v9
    v_mad_u32_u24 v9, v9, s44, v6
    ds_write_b32 v7, v100 offset:7216
    v_mad_u32_u24 v160, v9, s46, v15
    v_add_u32 v6, 16, v6
    v_mul_u32_u24 v9, 4682, v6
    ds_write_b32 v7, v101 offset:7616
    s_add_u32 m0, s79, s72
    s_nop 0
    buffer_load_dwordx4 v8, s[12:15], s72 offen lds
    v_lshrrev_b32 v9, 16, v9
    v_mad_u32_u24 v9, v9, s44, v6
    v_mad_u32_u24 v161, v9, s46, v15
    ds_write_b32 v7, v102 offset:8016
    v_mov_b32 v9, s47
    v_cmp_gt_u32 vcc, 196, v6
    s_nop 1
    ds_write_b32 v7, v103 offset:8416
    v_cndmask_b32 v161, v9, v161, vcc
    v_add_u32 v6, 16, v6
    v_mul_u32_u24 v9, 4682, v6
    ds_write_b32 v7, v104 offset:8816
    v_lshrrev_b32 v9, 16, v9
    v_mad_u32_u24 v9, v9, s44, v6
    v_mad_u32_u24 v162, v9, s46, v15
    ds_write_b32 v7, v105 offset:9216
    s_add_u32 m0, s79, s73
    s_nop 0
    buffer_load_dwordx4 v8, s[12:15], s73 offen lds
    v_mov_b32 v9, s47
    v_cmp_gt_u32 vcc, 196, v6
    s_nop 1
    ds_write_b32 v7, v106 offset:9616
    v_cndmask_b32 v162, v9, v162, vcc
    ds_write_b32 v7, v107 offset:10016
    ds_write_b32 v7, v108 offset:10416
    ds_write_b32 v7, v109 offset:10816
    v_readfirstlane_b32 s44, v5
    s_waitcnt lgkmcnt(0)
    s_barrier
    s_cmp_eq_u32 s40, 1
    s_cbranch_scc0 L_nq
    v_mov_b32 v9, 0
    buffer_load_dword v15, v9, s[32:35], 0 offen sc1
L_nq:
    ds_read_b128 v[16:19], v5 offset:0
    ds_read_b128 v[20:23], v5 offset:16
    ds_read_b128 v[24:27], v5 offset:128
    ds_read_b128 v[28:31], v5 offset:144
    ds_read_b128 v[32:35], v5 offset:256
    ds_read_b128 v[36:39], v5 offset:272
    v_add_u32 v6, s44, v4
    s_waitcnt lgkmcnt(0)
    v_pk_add_f32 v[40:41], v[16:17], v[22:23]
    v_pk_mul_f32 v[48:49], v[16:17], v[16:17]
    v_pk_add_f32 v[42:43], v[18:19], v[24:25]
    v_pk_mul_f32 v[50:51], v[18:19], v[18:19]
    v_pk_add_f32 v[44:45], v[20:21], v[26:27]
    v_pk_mul_f32 v[52:53], v[20:21], v[20:21]
    v_pk_fma_f32 v[48:49], v[22:23], v[22:23], v[48:49]
    v_pk_fma_f32 v[50:51], v[24:25], v[24:25], v[50:51]
    v_pk_fma_f32 v[52:53], v[26:27], v[26:27], v[52:53]
    v_pk_add_f32 v[40:41], v[40:41], v[28:29]
    v_pk_fma_f32 v[48:49], v[28:29], v[28:29], v[48:49]
    v_pk_add_f32 v[42:43], v[42:43], v[30:31]
    v_pk_fma_f32 v[50:51], v[30:31], v[30:31], v[50:51]
    v_pk_add_f32 v[44:45], v[44:45], v[32:33]
    v_pk_fma_f32 v[52:53], v[32:33], v[32:33], v[52:53]
    v_pk_add_f32 v[40:41], v[40:41], v[34:35]
    v_pk_fma_f32 v[48:49], v[34:35], v[34:35], v[48:49]
    v_pk_add_f32 v[42:43], v[42:43], v[36:37]
    v_pk_fma_f32 v[50:51], v[36:37], v[36:37], v[50:51]
    v_pk_add_f32 v[44:45], v[44:45], v[38:39]
    v_pk_fma_f32 v[52:53], v[38:39], v[38:39], v[52:53]
    v_pk_add_f32 v[40:41], v[40:41], v[42:43]
    v_pk_add_f32 v[48:49], v[48:49], v[50:51]
    v_pk_add_f32 v[40:41], v[40:41], v[44:45]
    v_pk_add_f32 v[48:49], v[48:49], v[52:53]
    v_add_f32 v40, v40, v41
    v_add_f32 v48, v48, v49
    v_mov_b32 v41, v40
    v_mov_b32 v49, v48
    s_nop 1
    v_permlane16_swap_b32 v40, v41
    v_permlane16_swap_b32 v48, v49
    s_nop 1
    v_add_f32 v40, v40, v41
    v_add_f32 v48, v48, v49
    v_mov_b32 v41, v40
    v_mov_b32 v49, v48
    s_nop 1
    v_permlane32_swap_b32 v40, v41
    v_permlane32_swap_b32 v48, v49
    s_nop 1
    v_add_f32 v40, v40, v41
    v_add_f32 v48, v48, v49
    v_mul_f32 v40, v40, v12
    v_mul_f32 v41, v40, v40
    v_fma_f32 v48, -v48, v12, -v41
    v_max_f32 v48, 0, v48
    v_fma_f32 v48, v48, v13, v14
    v_rsq_f32 v48, v48
    s_nop 0
    v_mul_f32 v40, v40, v48
    v_pk_fma_f32 v[16:17], v[16:17], v[48:49], v[40:41] op_sel_hi:[1,0,0]
    v_pk_fma_f32 v[18:19], v[18:19], v[48:49], v[40:41] op_sel_hi:[1,0,0]
    v_pk_fma_f32 v[20:21], v[20:21], v[48:49], v[40:41] op_sel_hi:[1,0,0]
    v_pk_fma_f32 v[22:23], v[22:23], v[48:49], v[40:41] op_sel_hi:[1,0,0]
    v_pk_fma_f32 v[24:25], v[24:25], v[48:49], v[40:41] op_sel_hi:[1,0,0]
    v_pk_fma_f32 v[26:27], v[26:27], v[48:49], v[40:41] op_sel_hi:[1,0,0]
    v_pk_fma_f32 v[28:29], v[28:29], v[48:49], v[40:41] op_sel_hi:[1,0,0]
    v_pk_fma_f32 v[30:31], v[30:31], v[48:49], v[40:41] op_sel_hi:[1,0,0]
    v_pk_fma_f32 v[32:33], v[32:33], v[48:49], v[40:41] op_sel_hi:[1,0,0]
    v_pk_fma_f32 v[34:35], v[34:35], v[48:49], v[40:41] op_sel_hi:[1,0,0]
    v_pk_fma_f32 v[36:37], v[36:37], v[48:49], v[40:41] op_sel_hi:[1,0,0]
    v_pk_fma_f32 v[38:39], v[38:39], v[48:49], v[40:41] op_sel_hi:[1,0,0]
    v_cvt_pk_bf16_f32 v40, v16, v17
    v_cvt_pk_bf16_f32 v41, v18, v19
    v_cvt_pk_bf16_f32 v42, v20, v21
    v_cvt_pk_bf16_f32 v43, v22, v23
    v_cvt_pk_bf16_f32 v44, v24, v25
    v_cvt_pk_bf16_f32 v45, v26, v27
    v_cvt_pk_bf16_f32 v46, v28, v29
    v_cvt_pk_bf16_f32 v47, v30, v31
    v_cvt_pk_bf16_f32 v48, v32, v33
    v_cvt_pk_bf16_f32 v49, v34, v35
    v_cvt_pk_bf16_f32 v50, v36, v37
    v_cvt_pk_bf16_f32 v51, v38, v39
    ds_write_b128 v6, v[40:43] offset:0
    ds_write_b128 v6, v[44:47] offset:1024
    ds_write_b128 v6, v[48:51] offset:2048
    s_cmp_eq_u32 s40, 0
    s_cbranch_scc0 L_ln1
    v_min_u32 v5, 3, v2
    v_add_u32 v5, 192, v5
    v_mul_u32_u24 v10, 4682, v5
    v_lshrrev_b32 v10, 16, v10
    v_mul_u32_u24 v11, 14, v10
    v_sub_u32 v11, v5, v11
    v_lshrrev_b32 v5, 2, v10
    v_mul_u32_u24 v5, 32, v5
    v_mul_u32_u24 v10, 5616, v10
    v_add_u32 v10, v10, v5
    v_mul_u32_u24 v11, 400, v11
    v_add_u32 v10, 77888, v10
    v_lshl_add_u32 v11, v3, 5, v11
    v_add_u32 v5, v10, v11
    s_mov_b32 s44, 154992
    s_waitcnt lgkmcnt(0)
    ds_read_b128 v[16:19], v5 offset:0
    ds_read_b128 v[20:23], v5 offset:16
    ds_read_b128 v[24:27], v5 offset:128
    ds_read_b128 v[28:31], v5 offset:144
    ds_read_b128 v[32:35], v5 offset:256
    ds_read_b128 v[36:39], v5 offset:272
    v_add_u32 v6, s44, v4
    s_waitcnt lgkmcnt(0)
    v_pk_add_f32 v[40:41], v[16:17], v[22:23]
    v_pk_mul_f32 v[48:49], v[16:17], v[16:17]
    v_pk_add_f32 v[42:43], v[18:19], v[24:25]
    v_pk_mul_f32 v[50:51], v[18:19], v[18:19]
    v_pk_add_f32 v[44:45], v[20:21], v[26:27]
    v_pk_mul_f32 v[52:53], v[20:21], v[20:21]
    v_pk_fma_f32 v[48:49], v[22:23], v[22:23], v[48:49]
    v_pk_fma_f32 v[50:51], v[24:25], v[24:25], v[50:51]
    v_pk_fma_f32 v[52:53], v[26:27], v[26:27], v[52:53]
    v_pk_add_f32 v[40:41], v[40:41], v[28:29]
    v_pk_fma_f32 v[48:49], v[28:29], v[28:29], v[48:49]
    v_pk_add_f32 v[42:43], v[42:43], v[30:31]
    v_pk_fma_f32 v[50:51], v[30:31], v[30:31], v[50:51]
    v_pk_add_f32 v[44:45], v[44:45], v[32:33]
    v_pk_fma_f32 v[52:53], v[32:33], v[32:33], v[52:53]
    v_pk_add_f32 v[40:41], v[40:41], v[34:35]
    v_pk_fma_f32 v[48:49], v[34:35], v[34:35], v[48:49]
    v_pk_add_f32 v[42:43], v[42:43], v[36:37]
    v_pk_fma_f32 v[50:51], v[36:37], v[36:37], v[50:51]
    v_pk_add_f32 v[44:45], v[44:45], v[38:39]
    v_pk_fma_f32 v[52:53], v[38:39], v[38:39], v[52:53]
    v_pk_add_f32 v[40:41], v[40:41], v[42:43]
    v_pk_add_f32 v[48:49], v[48:49], v[50:51]
    v_pk_add_f32 v[40:41], v[40:41], v[44:45]
    v_pk_add_f32 v[48:49], v[48:49], v[52:53]
    v_add_f32 v40, v40, v41
    v_add_f32 v48, v48, v49
    v_mov_b32 v41, v40
    v_mov_b32 v49, v48
    s_nop 1
    v_permlane16_swap_b32 v40, v41
    v_permlane16_swap_b32 v48, v49
    s_nop 1
    v_add_f32 v40, v40, v41
    v_add_f32 v48, v48, v49
    v_mov_b32 v41, v40
    v_mov_b32 v49, v48
    s_nop 1
    v_permlane32_swap_b32 v40, v41
    v_permlane32_swap_b32 v48, v49
    s_nop 1
    v_add_f32 v40, v40, v41
    v_add_f32 v48, v48, v49
    v_mul_f32 v40, v40, v12
    v_mul_f32 v41, v40, v40
    v_fma_f32 v48, -v48, v12, -v41
    v_max_f32 v48, 0, v48
    v_fma_f32 v48, v48, v13, v14
    v_rsq_f32 v48, v48
    s_nop 0
    v_mul_f32 v40, v40, v48
    v_pk_fma_f32 v[16:17], v[16:17], v[48:49], v[40:41] op_sel_hi:[1,0,0]
    v_pk_fma_f32 v[18:19], v[18:19], v[48:49], v[40:41] op_sel_hi:[1,0,0]
    v_pk_fma_f32 v[20:21], v[20:21], v[48:49], v[40:41] op_sel_hi:[1,0,0]
    v_pk_fma_f32 v[22:23], v[22:23], v[48:49], v[40:41] op_sel_hi:[1,0,0]
    v_pk_fma_f32 v[24:25], v[24:25], v[48:49], v[40:41] op_sel_hi:[1,0,0]
    v_pk_fma_f32 v[26:27], v[26:27], v[48:49], v[40:41] op_sel_hi:[1,0,0]
    v_pk_fma_f32 v[28:29], v[28:29], v[48:49], v[40:41] op_sel_hi:[1,0,0]
    v_pk_fma_f32 v[30:31], v[30:31], v[48:49], v[40:41] op_sel_hi:[1,0,0]
    v_pk_fma_f32 v[32:33], v[32:33], v[48:49], v[40:41] op_sel_hi:[1,0,0]
    v_pk_fma_f32 v[34:35], v[34:35], v[48:49], v[40:41] op_sel_hi:[1,0,0]
    v_pk_fma_f32 v[36:37], v[36:37], v[48:49], v[40:41] op_sel_hi:[1,0,0]
    v_pk_fma_f32 v[38:39], v[38:39], v[48:49], v[40:41] op_sel_hi:[1,0,0]
    v_cvt_pk_bf16_f32 v40, v16, v17
    v_cvt_pk_bf16_f32 v41, v18, v19
    v_cvt_pk_bf16_f32 v42, v20, v21
    v_cvt_pk_bf16_f32 v43, v22, v23
    v_cvt_pk_bf16_f32 v44, v24, v25
    v_cvt_pk_bf16_f32 v45, v26, v27
    v_cvt_pk_bf16_f32 v46, v28, v29
    v_cvt_pk_bf16_f32 v47, v30, v31
    v_cvt_pk_bf16_f32 v48, v32, v33
    v_cvt_pk_bf16_f32 v49, v34, v35
    v_cvt_pk_bf16_f32 v50, v36, v37
    v_cvt_pk_bf16_f32 v51, v38, v39
    v_cmp_gt_u32 vcc, 4, v2
    s_nop 1
    v_cndmask_b32 v40, 0, v40, vcc
    v_cndmask_b32 v41, 0, v41, vcc
    v_cndmask_b32 v42, 0, v42, vcc
    v_cndmask_b32 v43, 0, v43, vcc
    v_cndmask_b32 v44, 0, v44, vcc
    v_cndmask_b32 v45, 0, v45, vcc
    v_cndmask_b32 v46, 0, v46, vcc
    v_cndmask_b32 v47, 0, v47, vcc
    v_cndmask_b32 v48, 0, v48, vcc
    v_cndmask_b32 v49, 0, v49, vcc
    v_cndmask_b32 v50, 0, v50, vcc
    v_cndmask_b32 v51, 0, v51, vcc
    ds_write_b128 v6, v[40:43] offset:0
    ds_write_b128 v6, v[44:47] offset:1024
    ds_write_b128 v6, v[48:51] offset:2048
L_ln1:
    s_cmp_eq_u32 s40, 1
    s_cbranch_scc0 L_ln2
    s_mov_b32 s76, 131072
    s_branch L_p0b
L_p0:
    buffer_load_dword v15, v9, s[32:35], 0 offen sc1
L_p0b:
    s_waitcnt vmcnt(0)
    v_readfirstlane_b32 s44, v15
    s_cmp_ge_u32 s44, 256
    s_cbranch_scc1 L_ln2
    s_sub_u32 s76, s76, 1
    s_cmp_eq_u32 s76, 0
    s_cbranch_scc0 L_p0
L_ln2:
    v_bfe_u32 v9, v1, 2, 2
    v_lshl_add_u32 v10, v3, 3, v9
    v_mul_u32_u24 v10, 768, v10
    v_and_b32 v11, 3, v1
    v_lshl_add_u32 v10, v11, 3, v10
    v_and_b32 v11, 1, v3
    v_lshl_or_b32 v9, v11, 2, v9
    s_lshl_b32 s43, s40, 1
    v_xor_b32 v11, s43, v9
    v_lshl_add_u32 v5, v11, 5, v10
    v_xor_b32 v11, 1, v11
    v_lshl_add_u32 v6, v11, 5, v10
    v_add_u32 v7, 77888, v4
    v_add_u32 v8, 117888, v4
    v_mov_b32 v164, 0xc09d30fc
    v_mov_b32 v165, 0xc09d30fc
    v_mov_b32 v166, 1.0
    v_mov_b32 v167, 1.0
    v_mov_b32 v96, 0
    v_mov_b32 v97, 0
    v_mov_b32 v98, 0
    v_mov_b32 v99, 0
    v_mov_b32 v100, 0
    v_mov_b32 v101, 0
    v_mov_b32 v102, 0
    v_mov_b32 v103, 0
    v_mul_u32_u24 v9, 43691, v0
    v_lshrrev_b32 v9, 21, v9
    v_and_b32 v9, 1, v9
    v_lshlrev_b32 v9, 1, v9
    v_mul_u32_u24 v10, 43691, v0
    v_lshrrev_b32 v10, 19, v10
    v_mul_u32_u24 v10, 12, v10
    v_sub_u32 v11, v0, v10
    v_xor_b32 v9, v9, v11
    v_add_u32 v9, v9, v10
    v_lshlrev_b32 v9, 4, v9
    s_waitcnt vmcnt(0) lgkmcnt(0)
    s_barrier
    ds_read_b64_tr_b16 v[16:17], v5 offset:0
    ds_read_b64_tr_b16 v[18:19], v5 offset:3072
    ds_read_b64_tr_b16 v[20:21], v5 offset:24576
    ds_read_b64_tr_b16 v[22:23], v5 offset:27648
    ds_read_b64_tr_b16 v[24:25], v5 offset:49152
    ds_read_b64_tr_b16 v[26:27], v5 offset:52224
    ds_read_b64_tr_b16 v[28:29], v6 offset:0
    ds_read_b64_tr_b16 v[30:31], v6 offset:3072
    ds_read_b64_tr_b16 v[32:33], v6 offset:24576
    ds_read_b64_tr_b16 v[34:35], v6 offset:27648
    ds_read_b64_tr_b16 v[36:37], v6 offset:49152
    ds_read_b64_tr_b16 v[38:39], v6 offset:52224
    ds_read_b128 v[40:43], v7 offset:0
    ds_read_b128 v[44:47], v7 offset:1024
    ds_read_b128 v[48:51], v7 offset:2048
    ds_read_b128 v[52:55], v7 offset:6416
    ds_read_b128 v[56:59], v7 offset:7440
    ds_read_b128 v[60:63], v7 offset:8464
    s_waitcnt lgkmcnt(6)
    s_barrier
    s_lshl_b32 s43, s40, 10
    s_add_u32 m0, s43, s68
    s_nop 0
    buffer_load_dwordx4 v9, s[16:19], s68 offen lds
    s_add_u32 m0, s43, s69
    s_nop 0
    buffer_load_dwordx4 v9, s[16:19], s69 offen lds
    s_add_u32 m0, s43, s70
    s_nop 0
    buffer_load_dwordx4 v9, s[16:19], s70 offen lds
    s_add_u32 m0, s43, s71
    s_nop 0
    buffer_load_dwordx4 v9, s[16:19], s71 offen lds
    s_add_u32 m0, s43, s72
    s_nop 0
    buffer_load_dwordx4 v9, s[16:19], s72 offen lds
    s_add_u32 m0, s43, s73
    s_nop 0
    buffer_load_dwordx4 v9, s[16:19], s73 offen lds
    s_waitcnt lgkmcnt(3)
    v_mfma_f32_16x16x32_bf16 v[64:67], v[16:19], v[40:43], 0
    v_mfma_f32_16x16x32_bf16 v[68:71], v[28:31], v[40:43], 0
    v_mfma_f32_16x16x32_bf16 v[64:67], v[20:23], v[44:47], v[64:67]
    v_mfma_f32_16x16x32_bf16 v[68:71], v[32:35], v[44:47], v[68:71]
    v_mfma_f32_16x16x32_bf16 v[64:67], v[24:27], v[48:51], v[64:67]
    v_mfma_f32_16x16x32_bf16 v[68:71], v[36:39], v[48:51], v[68:71]
    s_nop 7
    v_pk_fma_f32 v[80:81], v[64:65], v[64:65], v[164:165] neg_lo:[1,0,0] neg_hi:[1,0,0]
    v_pk_fma_f32 v[82:83], v[66:67], v[66:67], v[164:165] neg_lo:[1,0,0] neg_hi:[1,0,0]
    v_pk_fma_f32 v[84:85], v[68:69], v[68:69], v[164:165] neg_lo:[1,0,0] neg_hi:[1,0,0]
    v_pk_fma_f32 v[86:87], v[70:71], v[70:71], v[164:165] neg_lo:[1,0,0] neg_hi:[1,0,0]
    v_pk_mul_f32 v[80:81], v[64:65], v[80:81]
    v_pk_mul_f32 v[82:83], v[66:67], v[82:83]
    v_pk_mul_f32 v[84:85], v[68:69], v[84:85]
    v_pk_mul_f32 v[86:87], v[70:71], v[86:87]
    s_waitcnt lgkmcnt(0)
    v_mfma_f32_16x16x32_bf16 v[72:75], v[16:19], v[52:55], 0
    v_exp_f32 v80, v80
    v_mfma_f32_16x16x32_bf16 v[76:79], v[28:31], v[52:55], 0
    v_exp_f32 v81, v81
    v_mfma_f32_16x16x32_bf16 v[72:75], v[20:23], v[56:59], v[72:75]
    v_exp_f32 v82, v82
    v_exp_f32 v83, v83
    v_exp_f32 v84, v84
    v_exp_f32 v85, v85
    v_exp_f32 v86, v86
    v_exp_f32 v87, v87
    v_pk_add_f32 v[80:81], v[80:81], v[166:167]
    v_pk_add_f32 v[82:83], v[82:83], v[166:167]
    v_pk_add_f32 v[84:85], v[84:85], v[166:167]
    v_pk_add_f32 v[86:87], v[86:87], v[166:167]
    v_mfma_f32_16x16x32_bf16 v[76:79], v[32:35], v[56:59], v[76:79]
    v_rcp_f32 v80, v80
    v_mfma_f32_16x16x32_bf16 v[72:75], v[24:27], v[60:63], v[72:75]
    v_rcp_f32 v81, v81
    v_mfma_f32_16x16x32_bf16 v[76:79], v[36:39], v[60:63], v[76:79]
    v_rcp_f32 v82, v82
    v_rcp_f32 v83, v83
    ds_read_b128 v[40:43], v7 offset:12832
    ds_read_b128 v[44:47], v7 offset:13856
    ds_read_b128 v[48:51], v7 offset:14880
    v_rcp_f32 v84, v84
    v_rcp_f32 v85, v85
    v_rcp_f32 v86, v86
    v_rcp_f32 v87, v87
    v_pk_mul_f32 v[80:81], v[64:65], v[80:81]
    v_pk_mul_f32 v[82:83], v[66:67], v[82:83]
    v_pk_mul_f32 v[84:85], v[68:69], v[84:85]
    v_pk_mul_f32 v[86:87], v[70:71], v[86:87]
    v_pk_fma_f32 v[96:97], v[80:81], v[80:81], v[96:97]
    v_pk_fma_f32 v[98:99], v[82:83], v[82:83], v[98:99]
    v_pk_fma_f32 v[100:101], v[84:85], v[84:85], v[100:101]
    v_pk_fma_f32 v[102:103], v[86:87], v[86:87], v[102:103]
    v_cvt_pk_bf16_f32 v104, v80, v81
    v_cvt_pk_bf16_f32 v105, v82, v83
    v_cvt_pk_bf16_f32 v106, v84, v85
    v_cvt_pk_bf16_f32 v107, v86, v87
    v_pk_fma_f32 v[88:89], v[72:73], v[72:73], v[164:165] neg_lo:[1,0,0] neg_hi:[1,0,0]
    v_pk_fma_f32 v[90:91], v[74:75], v[74:75], v[164:165] neg_lo:[1,0,0] neg_hi:[1,0,0]
    v_pk_fma_f32 v[92:93], v[76:77], v[76:77], v[164:165] neg_lo:[1,0,0] neg_hi:[1,0,0]
    v_pk_fma_f32 v[94:95], v[78:79], v[78:79], v[164:165] neg_lo:[1,0,0] neg_hi:[1,0,0]
    v_pk_mul_f32 v[88:89], v[72:73], v[88:89]
    v_pk_mul_f32 v[90:91], v[74:75], v[90:91]
    v_pk_mul_f32 v[92:93], v[76:77], v[92:93]
    v_pk_mul_f32 v[94:95], v[78:79], v[94:95]
    s_waitcnt lgkmcnt(0)
    v_mfma_f32_16x16x32_bf16 v[64:67], v[16:19], v[40:43], 0
    v_exp_f32 v88, v88
    v_mfma_f32_16x16x32_bf16 v[68:71], v[28:31], v[40:43], 0
    v_exp_f32 v89, v89
    v_mfma_f32_16x16x32_bf16 v[64:67], v[20:23], v[44:47], v[64:67]
    v_exp_f32 v90, v90
    v_exp_f32 v91, v91
    v_exp_f32 v92, v92
    v_exp_f32 v93, v93
    v_exp_f32 v94, v94
    v_exp_f32 v95, v95
    v_pk_add_f32 v[88:89], v[88:89], v[166:167]
    v_pk_add_f32 v[90:91], v[90:91], v[166:167]
    v_pk_add_f32 v[92:93], v[92:93], v[166:167]
    v_pk_add_f32 v[94:95], v[94:95], v[166:167]
    v_mfma_f32_16x16x32_bf16 v[68:71], v[32:35], v[44:47], v[68:71]
    v_rcp_f32 v88, v88
    v_mfma_f32_16x16x32_bf16 v[64:67], v[24:27], v[48:51], v[64:67]
    v_rcp_f32 v89, v89
    v_mfma_f32_16x16x32_bf16 v[68:71], v[36:39], v[48:51], v[68:71]
    v_rcp_f32 v90, v90
    v_rcp_f32 v91, v91
    ds_read_b128 v[52:55], v7 offset:19248
    ds_read_b128 v[56:59], v7 offset:20272
    ds_read_b128 v[60:63], v7 offset:21296
    v_rcp_f32 v92, v92
    v_rcp_f32 v93, v93
    v_rcp_f32 v94, v94
    v_rcp_f32 v95, v95
    v_pk_mul_f32 v[88:89], v[72:73], v[88:89]
    v_pk_mul_f32 v[90:91], v[74:75], v[90:91]
    v_pk_mul_f32 v[92:93], v[76:77], v[92:93]
    v_pk_mul_f32 v[94:95], v[78:79], v[94:95]
    v_pk_fma_f32 v[96:97], v[88:89], v[88:89], v[96:97]
    v_pk_fma_f32 v[98:99], v[90:91], v[90:91], v[98:99]
    v_pk_fma_f32 v[100:101], v[92:93], v[92:93], v[100:101]
    v_pk_fma_f32 v[102:103], v[94:95], v[94:95], v[102:103]
    v_cvt_pk_bf16_f32 v108, v88, v89
    v_cvt_pk_bf16_f32 v109, v90, v91
    v_cvt_pk_bf16_f32 v110, v92, v93
    v_cvt_pk_bf16_f32 v111, v94, v95
    v_pk_fma_f32 v[80:81], v[64:65], v[64:65], v[164:165] neg_lo:[1,0,0] neg_hi:[1,0,0]
    v_pk_fma_f32 v[82:83], v[66:67], v[66:67], v[164:165] neg_lo:[1,0,0] neg_hi:[1,0,0]
    v_pk_fma_f32 v[84:85], v[68:69], v[68:69], v[164:165] neg_lo:[1,0,0] neg_hi:[1,0,0]
    v_pk_fma_f32 v[86:87], v[70:71], v[70:71], v[164:165] neg_lo:[1,0,0] neg_hi:[1,0,0]
    v_pk_mul_f32 v[80:81], v[64:65], v[80:81]
    v_pk_mul_f32 v[82:83], v[66:67], v[82:83]
    v_pk_mul_f32 v[84:85], v[68:69], v[84:85]
    v_pk_mul_f32 v[86:87], v[70:71], v[86:87]
    s_waitcnt lgkmcnt(0)
    v_mfma_f32_16x16x32_bf16 v[72:75], v[16:19], v[52:55], 0
    v_exp_f32 v80, v80
    v_mfma_f32_16x16x32_bf16 v[76:79], v[28:31], v[52:55], 0
    v_exp_f32 v81, v81
    v_mfma_f32_16x16x32_bf16 v[72:75], v[20:23], v[56:59], v[72:75]
    v_exp_f32 v82, v82
    v_exp_f32 v83, v83
    v_exp_f32 v84, v84
    v_exp_f32 v85, v85
    v_exp_f32 v86, v86
    v_exp_f32 v87, v87
    v_pk_add_f32 v[80:81], v[80:81], v[166:167]
    v_pk_add_f32 v[82:83], v[82:83], v[166:167]
    v_pk_add_f32 v[84:85], v[84:85], v[166:167]
    v_pk_add_f32 v[86:87], v[86:87], v[166:167]
    v_mfma_f32_16x16x32_bf16 v[76:79], v[32:35], v[56:59], v[76:79]
    v_rcp_f32 v80, v80
    v_mfma_f32_16x16x32_bf16 v[72:75], v[24:27], v[60:63], v[72:75]
    v_rcp_f32 v81, v81
    v_mfma_f32_16x16x32_bf16 v[76:79], v[36:39], v[60:63], v[76:79]
    v_rcp_f32 v82, v82
    v_rcp_f32 v83, v83
    ds_read_b128 v[40:43], v7 offset:25696
    ds_read_b128 v[44:47], v7 offset:26720
    ds_read_b128 v[48:51], v7 offset:27744
    v_rcp_f32 v84, v84
    v_rcp_f32 v85, v85
    v_rcp_f32 v86, v86
    v_rcp_f32 v87, v87
    v_pk_mul_f32 v[80:81], v[64:65], v[80:81]
    v_pk_mul_f32 v[82:83], v[66:67], v[82:83]
    v_pk_mul_f32 v[84:85], v[68:69], v[84:85]
    v_pk_mul_f32 v[86:87], v[70:71], v[86:87]
    v_pk_fma_f32 v[96:97], v[80:81], v[80:81], v[96:97]
    v_pk_fma_f32 v[98:99], v[82:83], v[82:83], v[98:99]
    v_pk_fma_f32 v[100:101], v[84:85], v[84:85], v[100:101]
    v_pk_fma_f32 v[102:103], v[86:87], v[86:87], v[102:103]
    v_cvt_pk_bf16_f32 v112, v80, v81
    v_cvt_pk_bf16_f32 v113, v82, v83
    v_cvt_pk_bf16_f32 v114, v84, v85
    v_cvt_pk_bf16_f32 v115, v86, v87
    v_pk_fma_f32 v[88:89], v[72:73], v[72:73], v[164:165] neg_lo:[1,0,0] neg_hi:[1,0,0]
    v_pk_fma_f32 v[90:91], v[74:75], v[74:75], v[164:165] neg_lo:[1,0,0] neg_hi:[1,0,0]
    v_pk_fma_f32 v[92:93], v[76:77], v[76:77], v[164:165] neg_lo:[1,0,0] neg_hi:[1,0,0]
    v_pk_fma_f32 v[94:95], v[78:79], v[78:79], v[164:165] neg_lo:[1,0,0] neg_hi:[1,0,0]
    v_pk_mul_f32 v[88:89], v[72:73], v[88:89]
    v_pk_mul_f32 v[90:91], v[74:75], v[90:91]
    v_pk_mul_f32 v[92:93], v[76:77], v[92:93]
    v_pk_mul_f32 v[94:95], v[78:79], v[94:95]
    s_waitcnt lgkmcnt(0)
    v_mfma_f32_16x16x32_bf16 v[64:67], v[16:19], v[40:43], 0
    v_exp_f32 v88, v88
    v_mfma_f32_16x16x32_bf16 v[68:71], v[28:31], v[40:43], 0
    v_exp_f32 v89, v89
    v_mfma_f32_16x16x32_bf16 v[64:67], v[20:23], v[44:47], v[64:67]
    v_exp_f32 v90, v90
    v_exp_f32 v91, v91
    v_exp_f32 v92, v92
    v_exp_f32 v93, v93
    v_exp_f32 v94, v94
    v_exp_f32 v95, v95
    v_pk_add_f32 v[88:89], v[88:89], v[166:167]
    v_pk_add_f32 v[90:91], v[90:91], v[166:167]
    v_pk_add_f32 v[92:93], v[92:93], v[166:167]
    v_pk_add_f32 v[94:95], v[94:95], v[166:167]
    v_mfma_f32_16x16x32_bf16 v[68:71], v[32:35], v[44:47], v[68:71]
    v_rcp_f32 v88, v88
    v_mfma_f32_16x16x32_bf16 v[64:67], v[24:27], v[48:51], v[64:67]
    v_rcp_f32 v89, v89
    v_mfma_f32_16x16x32_bf16 v[68:71], v[36:39], v[48:51], v[68:71]
    v_rcp_f32 v90, v90
    v_rcp_f32 v91, v91
    ds_read_b128 v[52:55], v7 offset:32112
    ds_read_b128 v[56:59], v7 offset:33136
    ds_read_b128 v[60:63], v7 offset:34160
    v_rcp_f32 v92, v92
    v_rcp_f32 v93, v93
    v_rcp_f32 v94, v94
    v_rcp_f32 v95, v95
    v_pk_mul_f32 v[88:89], v[72:73], v[88:89]
    v_pk_mul_f32 v[90:91], v[74:75], v[90:91]
    v_pk_mul_f32 v[92:93], v[76:77], v[92:93]
    v_pk_mul_f32 v[94:95], v[78:79], v[94:95]
    v_pk_fma_f32 v[96:97], v[88:89], v[88:89], v[96:97]
    v_pk_fma_f32 v[98:99], v[90:91], v[90:91], v[98:99]
    v_pk_fma_f32 v[100:101], v[92:93], v[92:93], v[100:101]
    v_pk_fma_f32 v[102:103], v[94:95], v[94:95], v[102:103]
    v_cvt_pk_bf16_f32 v116, v88, v89
    v_cvt_pk_bf16_f32 v117, v90, v91
    v_cvt_pk_bf16_f32 v118, v92, v93
    v_cvt_pk_bf16_f32 v119, v94, v95
    v_pk_fma_f32 v[80:81], v[64:65], v[64:65], v[164:165] neg_lo:[1,0,0] neg_hi:[1,0,0]
    v_pk_fma_f32 v[82:83], v[66:67], v[66:67], v[164:165] neg_lo:[1,0,0] neg_hi:[1,0,0]
    v_pk_fma_f32 v[84:85], v[68:69], v[68:69], v[164:165] neg_lo:[1,0,0] neg_hi:[1,0,0]
    v_pk_fma_f32 v[86:87], v[70:71], v[70:71], v[164:165] neg_lo:[1,0,0] neg_hi:[1,0,0]
    v_pk_mul_f32 v[80:81], v[64:65], v[80:81]
    v_pk_mul_f32 v[82:83], v[66:67], v[82:83]
    v_pk_mul_f32 v[84:85], v[68:69], v[84:85]
    v_pk_mul_f32 v[86:87], v[70:71], v[86:87]
    s_waitcnt lgkmcnt(0)
    v_mfma_f32_16x16x32_bf16 v[72:75], v[16:19], v[52:55], 0
    v_exp_f32 v80, v80
    v_mfma_f32_16x16x32_bf16 v[76:79], v[28:31], v[52:55], 0
    v_exp_f32 v81, v81
    v_mfma_f32_16x16x32_bf16 v[72:75], v[20:23], v[56:59], v[72:75]
    v_exp_f32 v82, v82
    v_exp_f32 v83, v83
    v_exp_f32 v84, v84
    v_exp_f32 v85, v85
    v_exp_f32 v86, v86
    v_exp_f32 v87, v87
    v_pk_add_f32 v[80:81], v[80:81], v[166:167]
    v_pk_add_f32 v[82:83], v[82:83], v[166:167]
    v_pk_add_f32 v[84:85], v[84:85], v[166:167]
    v_pk_add_f32 v[86:87], v[86:87], v[166:167]
    v_mfma_f32_16x16x32_bf16 v[76:79], v[32:35], v[56:59], v[76:79]
    v_rcp_f32 v80, v80
    v_mfma_f32_16x16x32_bf16 v[72:75], v[24:27], v[60:63], v[72:75]
    v_rcp_f32 v81, v81
    v_mfma_f32_16x16x32_bf16 v[76:79], v[36:39], v[60:63], v[76:79]
    v_rcp_f32 v82, v82
    v_rcp_f32 v83, v83
    ds_read_b128 v[40:43], v7 offset:38528
    ds_read_b128 v[44:47], v7 offset:39552
    ds_read_b128 v[48:51], v7 offset:40576
    v_rcp_f32 v84, v84
    v_rcp_f32 v85, v85
    v_rcp_f32 v86, v86
    v_rcp_f32 v87, v87
    v_pk_mul_f32 v[80:81], v[64:65], v[80:81]
    v_pk_mul_f32 v[82:83], v[66:67], v[82:83]
    v_pk_mul_f32 v[84:85], v[68:69], v[84:85]
    v_pk_mul_f32 v[86:87], v[70:71], v[86:87]
    v_pk_fma_f32 v[96:97], v[80:81], v[80:81], v[96:97]
    v_pk_fma_f32 v[98:99], v[82:83], v[82:83], v[98:99]
    v_pk_fma_f32 v[100:101], v[84:85], v[84:85], v[100:101]
    v_pk_fma_f32 v[102:103], v[86:87], v[86:87], v[102:103]
    v_cvt_pk_bf16_f32 v120, v80, v81
    v_cvt_pk_bf16_f32 v121, v82, v83
    v_cvt_pk_bf16_f32 v122, v84, v85
    v_cvt_pk_bf16_f32 v123, v86, v87
    v_pk_fma_f32 v[88:89], v[72:73], v[72:73], v[164:165] neg_lo:[1,0,0] neg_hi:[1,0,0]
    v_pk_fma_f32 v[90:91], v[74:75], v[74:75], v[164:165] neg_lo:[1,0,0] neg_hi:[1,0,0]
    v_pk_fma_f32 v[92:93], v[76:77], v[76:77], v[164:165] neg_lo:[1,0,0] neg_hi:[1,0,0]
    v_pk_fma_f32 v[94:95], v[78:79], v[78:79], v[164:165] neg_lo:[1,0,0] neg_hi:[1,0,0]
    v_pk_mul_f32 v[88:89], v[72:73], v[88:89]
    v_pk_mul_f32 v[90:91], v[74:75], v[90:91]
    v_pk_mul_f32 v[92:93], v[76:77], v[92:93]
    v_pk_mul_f32 v[94:95], v[78:79], v[94:95]
    s_waitcnt lgkmcnt(0)
    v_mfma_f32_16x16x32_bf16 v[64:67], v[16:19], v[40:43], 0
    v_exp_f32 v88, v88
    v_mfma_f32_16x16x32_bf16 v[68:71], v[28:31], v[40:43], 0
    v_exp_f32 v89, v89
    v_mfma_f32_16x16x32_bf16 v[64:67], v[20:23], v[44:47], v[64:67]
    v_exp_f32 v90, v90
    v_exp_f32 v91, v91
    v_exp_f32 v92, v92
    v_exp_f32 v93, v93
    v_exp_f32 v94, v94
    v_exp_f32 v95, v95
    v_pk_add_f32 v[88:89], v[88:89], v[166:167]
    v_pk_add_f32 v[90:91], v[90:91], v[166:167]
    v_pk_add_f32 v[92:93], v[92:93], v[166:167]
    v_pk_add_f32 v[94:95], v[94:95], v[166:167]
    v_mfma_f32_16x16x32_bf16 v[68:71], v[32:35], v[44:47], v[68:71]
    v_rcp_f32 v88, v88
    v_mfma_f32_16x16x32_bf16 v[64:67], v[24:27], v[48:51], v[64:67]
    v_rcp_f32 v89, v89
    v_mfma_f32_16x16x32_bf16 v[68:71], v[36:39], v[48:51], v[68:71]
    v_rcp_f32 v90, v90
    v_rcp_f32 v91, v91
    ds_read_b128 v[52:55], v7 offset:44992
    ds_read_b128 v[56:59], v7 offset:46016
    ds_read_b128 v[60:63], v7 offset:47040
    v_rcp_f32 v92, v92
    v_rcp_f32 v93, v93
    v_rcp_f32 v94, v94
    v_rcp_f32 v95, v95
    v_pk_mul_f32 v[88:89], v[72:73], v[88:89]
    v_pk_mul_f32 v[90:91], v[74:75], v[90:91]
    v_pk_mul_f32 v[92:93], v[76:77], v[92:93]
    v_pk_mul_f32 v[94:95], v[78:79], v[94:95]
    v_pk_fma_f32 v[96:97], v[88:89], v[88:89], v[96:97]
    v_pk_fma_f32 v[98:99], v[90:91], v[90:91], v[98:99]
    v_pk_fma_f32 v[100:101], v[92:93], v[92:93], v[100:101]
    v_pk_fma_f32 v[102:103], v[94:95], v[94:95], v[102:103]
    v_cvt_pk_bf16_f32 v124, v88, v89
    v_cvt_pk_bf16_f32 v125, v90, v91
    v_cvt_pk_bf16_f32 v126, v92, v93
    v_cvt_pk_bf16_f32 v127, v94, v95
    v_pk_fma_f32 v[80:81], v[64:65], v[64:65], v[164:165] neg_lo:[1,0,0] neg_hi:[1,0,0]
    v_pk_fma_f32 v[82:83], v[66:67], v[66:67], v[164:165] neg_lo:[1,0,0] neg_hi:[1,0,0]
    v_pk_fma_f32 v[84:85], v[68:69], v[68:69], v[164:165] neg_lo:[1,0,0] neg_hi:[1,0,0]
    v_pk_fma_f32 v[86:87], v[70:71], v[70:71], v[164:165] neg_lo:[1,0,0] neg_hi:[1,0,0]
    v_pk_mul_f32 v[80:81], v[64:65], v[80:81]
    v_pk_mul_f32 v[82:83], v[66:67], v[82:83]
    v_pk_mul_f32 v[84:85], v[68:69], v[84:85]
    v_pk_mul_f32 v[86:87], v[70:71], v[86:87]
    s_waitcnt lgkmcnt(0)
    v_mfma_f32_16x16x32_bf16 v[72:75], v[16:19], v[52:55], 0
    v_exp_f32 v80, v80
    v_mfma_f32_16x16x32_bf16 v[76:79], v[28:31], v[52:55], 0
    v_exp_f32 v81, v81
    v_mfma_f32_16x16x32_bf16 v[72:75], v[20:23], v[56:59], v[72:75]
    v_exp_f32 v82, v82
    v_exp_f32 v83, v83
    v_exp_f32 v84, v84
    v_exp_f32 v85, v85
    v_exp_f32 v86, v86
    v_exp_f32 v87, v87
    v_pk_add_f32 v[80:81], v[80:81], v[166:167]
    v_pk_add_f32 v[82:83], v[82:83], v[166:167]
    v_pk_add_f32 v[84:85], v[84:85], v[166:167]
    v_pk_add_f32 v[86:87], v[86:87], v[166:167]
    v_mfma_f32_16x16x32_bf16 v[76:79], v[32:35], v[56:59], v[76:79]
    v_rcp_f32 v80, v80
    v_mfma_f32_16x16x32_bf16 v[72:75], v[24:27], v[60:63], v[72:75]
    v_rcp_f32 v81, v81
    v_mfma_f32_16x16x32_bf16 v[76:79], v[36:39], v[60:63], v[76:79]
    v_rcp_f32 v82, v82
    v_rcp_f32 v83, v83
    ds_read_b128 v[40:43], v7 offset:51408
    ds_read_b128 v[44:47], v7 offset:52432
    ds_read_b128 v[48:51], v7 offset:53456
    v_rcp_f32 v84, v84
    v_rcp_f32 v85, v85
    v_rcp_f32 v86, v86
    v_rcp_f32 v87, v87
    v_pk_mul_f32 v[80:81], v[64:65], v[80:81]
    v_pk_mul_f32 v[82:83], v[66:67], v[82:83]
    v_pk_mul_f32 v[84:85], v[68:69], v[84:85]
    v_pk_mul_f32 v[86:87], v[70:71], v[86:87]
    v_pk_fma_f32 v[96:97], v[80:81], v[80:81], v[96:97]
    v_pk_fma_f32 v[98:99], v[82:83], v[82:83], v[98:99]
    v_pk_fma_f32 v[100:101], v[84:85], v[84:85], v[100:101]
    v_pk_fma_f32 v[102:103], v[86:87], v[86:87], v[102:103]
    v_cvt_pk_bf16_f32 v128, v80, v81
    v_cvt_pk_bf16_f32 v129, v82, v83
    v_cvt_pk_bf16_f32 v130, v84, v85
    v_cvt_pk_bf16_f32 v131, v86, v87
    v_pk_fma_f32 v[88:89], v[72:73], v[72:73], v[164:165] neg_lo:[1,0,0] neg_hi:[1,0,0]
    v_pk_fma_f32 v[90:91], v[74:75], v[74:75], v[164:165] neg_lo:[1,0,0] neg_hi:[1,0,0]
    v_pk_fma_f32 v[92:93], v[76:77], v[76:77], v[164:165] neg_lo:[1,0,0] neg_hi:[1,0,0]
    v_pk_fma_f32 v[94:95], v[78:79], v[78:79], v[164:165] neg_lo:[1,0,0] neg_hi:[1,0,0]
    v_pk_mul_f32 v[88:89], v[72:73], v[88:89]
    v_pk_mul_f32 v[90:91], v[74:75], v[90:91]
    v_pk_mul_f32 v[92:93], v[76:77], v[92:93]
    v_pk_mul_f32 v[94:95], v[78:79], v[94:95]
    s_waitcnt lgkmcnt(0)
    v_mfma_f32_16x16x32_bf16 v[64:67], v[16:19], v[40:43], 0
    v_exp_f32 v88, v88
    v_mfma_f32_16x16x32_bf16 v[68:71], v[28:31], v[40:43], 0
    v_exp_f32 v89, v89
    v_mfma_f32_16x16x32_bf16 v[64:67], v[20:23], v[44:47], v[64:67]
    v_exp_f32 v90, v90
    v_exp_f32 v91, v91
    v_exp_f32 v92, v92
    v_exp_f32 v93, v93
    v_exp_f32 v94, v94
    v_exp_f32 v95, v95
    v_pk_add_f32 v[88:89], v[88:89], v[166:167]
    v_pk_add_f32 v[90:91], v[90:91], v[166:167]
    v_pk_add_f32 v[92:93], v[92:93], v[166:167]
    v_pk_add_f32 v[94:95], v[94:95], v[166:167]
    v_mfma_f32_16x16x32_bf16 v[68:71], v[32:35], v[44:47], v[68:71]
    v_rcp_f32 v88, v88
    v_mfma_f32_16x16x32_bf16 v[64:67], v[24:27], v[48:51], v[64:67]
    v_rcp_f32 v89, v89
    v_mfma_f32_16x16x32_bf16 v[68:71], v[36:39], v[48:51], v[68:71]
    v_rcp_f32 v90, v90
    v_rcp_f32 v91, v91
    ds_read_b128 v[52:55], v7 offset:57824
    ds_read_b128 v[56:59], v7 offset:58848
    ds_read_b128 v[60:63], v7 offset:59872
    v_rcp_f32 v92, v92
    v_rcp_f32 v93, v93
    v_rcp_f32 v94, v94
    v_rcp_f32 v95, v95
    v_pk_mul_f32 v[88:89], v[72:73], v[88:89]
    v_pk_mul_f32 v[90:91], v[74:75], v[90:91]
    v_pk_mul_f32 v[92:93], v[76:77], v[92:93]
    v_pk_mul_f32 v[94:95], v[78:79], v[94:95]
    v_pk_fma_f32 v[96:97], v[88:89], v[88:89], v[96:97]
    v_pk_fma_f32 v[98:99], v[90:91], v[90:91], v[98:99]
    v_pk_fma_f32 v[100:101], v[92:93], v[92:93], v[100:101]
    v_pk_fma_f32 v[102:103], v[94:95], v[94:95], v[102:103]
    v_cvt_pk_bf16_f32 v132, v88, v89
    v_cvt_pk_bf16_f32 v133, v90, v91
    v_cvt_pk_bf16_f32 v134, v92, v93
    v_cvt_pk_bf16_f32 v135, v94, v95
    v_pk_fma_f32 v[80:81], v[64:65], v[64:65], v[164:165] neg_lo:[1,0,0] neg_hi:[1,0,0]
    v_pk_fma_f32 v[82:83], v[66:67], v[66:67], v[164:165] neg_lo:[1,0,0] neg_hi:[1,0,0]
    v_pk_fma_f32 v[84:85], v[68:69], v[68:69], v[164:165] neg_lo:[1,0,0] neg_hi:[1,0,0]
    v_pk_fma_f32 v[86:87], v[70:71], v[70:71], v[164:165] neg_lo:[1,0,0] neg_hi:[1,0,0]
    v_pk_mul_f32 v[80:81], v[64:65], v[80:81]
    v_pk_mul_f32 v[82:83], v[66:67], v[82:83]
    v_pk_mul_f32 v[84:85], v[68:69], v[84:85]
    v_pk_mul_f32 v[86:87], v[70:71], v[86:87]
    s_waitcnt lgkmcnt(0)
    v_mfma_f32_16x16x32_bf16 v[72:75], v[16:19], v[52:55], 0
    v_exp_f32 v80, v80
    v_mfma_f32_16x16x32_bf16 v[76:79], v[28:31], v[52:55], 0
    v_exp_f32 v81, v81
    v_mfma_f32_16x16x32_bf16 v[72:75], v[20:23], v[56:59], v[72:75]
    v_exp_f32 v82, v82
    v_exp_f32 v83, v83
    v_exp_f32 v84, v84
    v_exp_f32 v85, v85
    v_exp_f32 v86, v86
    v_exp_f32 v87, v87
    v_pk_add_f32 v[80:81], v[80:81], v[166:167]
    v_pk_add_f32 v[82:83], v[82:83], v[166:167]
    v_pk_add_f32 v[84:85], v[84:85], v[166:167]
    v_pk_add_f32 v[86:87], v[86:87], v[166:167]
    v_mfma_f32_16x16x32_bf16 v[76:79], v[32:35], v[56:59], v[76:79]
    v_rcp_f32 v80, v80
    v_mfma_f32_16x16x32_bf16 v[72:75], v[24:27], v[60:63], v[72:75]
    v_rcp_f32 v81, v81
    v_mfma_f32_16x16x32_bf16 v[76:79], v[36:39], v[60:63], v[76:79]
    v_rcp_f32 v82, v82
    v_rcp_f32 v83, v83
    ds_read_b128 v[40:43], v8 offset:24240
    ds_read_b128 v[44:47], v8 offset:25264
    ds_read_b128 v[48:51], v8 offset:26288
    v_rcp_f32 v84, v84
    v_rcp_f32 v85, v85
    v_rcp_f32 v86, v86
    v_rcp_f32 v87, v87
    v_pk_mul_f32 v[80:81], v[64:65], v[80:81]
    v_pk_mul_f32 v[82:83], v[66:67], v[82:83]
    v_pk_mul_f32 v[84:85], v[68:69], v[84:85]
    v_pk_mul_f32 v[86:87], v[70:71], v[86:87]
    v_pk_fma_f32 v[96:97], v[80:81], v[80:81], v[96:97]
    v_pk_fma_f32 v[98:99], v[82:83], v[82:83], v[98:99]
    v_pk_fma_f32 v[100:101], v[84:85], v[84:85], v[100:101]
    v_pk_fma_f32 v[102:103], v[86:87], v[86:87], v[102:103]
    v_cvt_pk_bf16_f32 v136, v80, v81
    v_cvt_pk_bf16_f32 v137, v82, v83
    v_cvt_pk_bf16_f32 v138, v84, v85
    v_cvt_pk_bf16_f32 v139, v86, v87
    s_waitcnt vmcnt(0) lgkmcnt(0)
    s_barrier
    v_pk_fma_f32 v[88:89], v[72:73], v[72:73], v[164:165] neg_lo:[1,0,0] neg_hi:[1,0,0]
    v_pk_fma_f32 v[90:91], v[74:75], v[74:75], v[164:165] neg_lo:[1,0,0] neg_hi:[1,0,0]
    v_pk_fma_f32 v[92:93], v[76:77], v[76:77], v[164:165] neg_lo:[1,0,0] neg_hi:[1,0,0]
    v_pk_fma_f32 v[94:95], v[78:79], v[78:79], v[164:165] neg_lo:[1,0,0] neg_hi:[1,0,0]
    v_pk_mul_f32 v[88:89], v[72:73], v[88:89]
    v_pk_mul_f32 v[90:91], v[74:75], v[90:91]
    v_pk_mul_f32 v[92:93], v[76:77], v[92:93]
    v_pk_mul_f32 v[94:95], v[78:79], v[94:95]
    s_waitcnt lgkmcnt(0)
    v_mfma_f32_16x16x32_bf16 v[64:67], v[16:19], v[40:43], 0
    v_exp_f32 v88, v88
    v_mfma_f32_16x16x32_bf16 v[68:71], v[28:31], v[40:43], 0
    v_exp_f32 v89, v89
    v_mfma_f32_16x16x32_bf16 v[64:67], v[20:23], v[44:47], v[64:67]
    v_exp_f32 v90, v90
    v_exp_f32 v91, v91
    v_exp_f32 v92, v92
    v_exp_f32 v93, v93
    v_exp_f32 v94, v94
    v_exp_f32 v95, v95
    v_pk_add_f32 v[88:89], v[88:89], v[166:167]
    v_pk_add_f32 v[90:91], v[90:91], v[166:167]
    v_pk_add_f32 v[92:93], v[92:93], v[166:167]
    v_pk_add_f32 v[94:95], v[94:95], v[166:167]
    v_mfma_f32_16x16x32_bf16 v[68:71], v[32:35], v[44:47], v[68:71]
    v_rcp_f32 v88, v88
    v_mfma_f32_16x16x32_bf16 v[64:67], v[24:27], v[48:51], v[64:67]
    v_rcp_f32 v89, v89
    v_mfma_f32_16x16x32_bf16 v[68:71], v[36:39], v[48:51], v[68:71]
    v_rcp_f32 v90, v90
    v_rcp_f32 v91, v91
    ds_read_b128 v[52:55], v8 offset:30688
    ds_read_b128 v[56:59], v8 offset:31712
    ds_read_b128 v[60:63], v8 offset:32736
    v_rcp_f32 v92, v92
    v_rcp_f32 v93, v93
    v_rcp_f32 v94, v94
    v_rcp_f32 v95, v95
    v_pk_mul_f32 v[88:89], v[72:73], v[88:89]
    v_pk_mul_f32 v[90:91], v[74:75], v[90:91]
    v_pk_mul_f32 v[92:93], v[76:77], v[92:93]
    v_pk_mul_f32 v[94:95], v[78:79], v[94:95]
    v_pk_fma_f32 v[96:97], v[88:89], v[88:89], v[96:97]
    v_pk_fma_f32 v[98:99], v[90:91], v[90:91], v[98:99]
    v_pk_fma_f32 v[100:101], v[92:93], v[92:93], v[100:101]
    v_pk_fma_f32 v[102:103], v[94:95], v[94:95], v[102:103]
    v_cvt_pk_bf16_f32 v140, v88, v89
    v_cvt_pk_bf16_f32 v141, v90, v91
    v_cvt_pk_bf16_f32 v142, v92, v93
    v_cvt_pk_bf16_f32 v143, v94, v95
    v_pk_fma_f32 v[80:81], v[64:65], v[64:65], v[164:165] neg_lo:[1,0,0] neg_hi:[1,0,0]
    v_pk_fma_f32 v[82:83], v[66:67], v[66:67], v[164:165] neg_lo:[1,0,0] neg_hi:[1,0,0]
    v_pk_fma_f32 v[84:85], v[68:69], v[68:69], v[164:165] neg_lo:[1,0,0] neg_hi:[1,0,0]
    v_pk_fma_f32 v[86:87], v[70:71], v[70:71], v[164:165] neg_lo:[1,0,0] neg_hi:[1,0,0]
    v_pk_mul_f32 v[80:81], v[64:65], v[80:81]
    v_pk_mul_f32 v[82:83], v[66:67], v[82:83]
    v_pk_mul_f32 v[84:85], v[68:69], v[84:85]
    v_pk_mul_f32 v[86:87], v[70:71], v[86:87]
    s_waitcnt lgkmcnt(0)
    v_mfma_f32_16x16x32_bf16 v[72:75], v[16:19], v[52:55], 0
    v_exp_f32 v80, v80
    v_mfma_f32_16x16x32_bf16 v[76:79], v[28:31], v[52:55], 0
    v_exp_f32 v81, v81
    v_mfma_f32_16x16x32_bf16 v[72:75], v[20:23], v[56:59], v[72:75]
    v_exp_f32 v82, v82
    v_exp_f32 v83, v83
    v_exp_f32 v84, v84
    v_exp_f32 v85, v85
    v_exp_f32 v86, v86
    v_exp_f32 v87, v87
    v_pk_add_f32 v[80:81], v[80:81], v[166:167]
    v_pk_add_f32 v[82:83], v[82:83], v[166:167]
    v_pk_add_f32 v[84:85], v[84:85], v[166:167]
    v_pk_add_f32 v[86:87], v[86:87], v[166:167]
    v_mfma_f32_16x16x32_bf16 v[76:79], v[32:35], v[56:59], v[76:79]
    v_rcp_f32 v80, v80
    v_mfma_f32_16x16x32_bf16 v[72:75], v[24:27], v[60:63], v[72:75]
    v_rcp_f32 v81, v81
    v_mfma_f32_16x16x32_bf16 v[76:79], v[36:39], v[60:63], v[76:79]
    v_rcp_f32 v82, v82
    v_rcp_f32 v83, v83
    ds_read_b128 v[40:43], v8 offset:37104
    ds_read_b128 v[44:47], v8 offset:38128
    ds_read_b128 v[48:51], v8 offset:39152
    v_rcp_f32 v84, v84
    v_rcp_f32 v85, v85
    v_rcp_f32 v86, v86
    v_rcp_f32 v87, v87
    v_pk_mul_f32 v[80:81], v[64:65], v[80:81]
    v_pk_mul_f32 v[82:83], v[66:67], v[82:83]
    v_pk_mul_f32 v[84:85], v[68:69], v[84:85]
    v_pk_mul_f32 v[86:87], v[70:71], v[86:87]
    v_pk_fma_f32 v[96:97], v[80:81], v[80:81], v[96:97]
    v_pk_fma_f32 v[98:99], v[82:83], v[82:83], v[98:99]
    v_pk_fma_f32 v[100:101], v[84:85], v[84:85], v[100:101]
    v_pk_fma_f32 v[102:103], v[86:87], v[86:87], v[102:103]
    v_cvt_pk_bf16_f32 v144, v80, v81
    v_cvt_pk_bf16_f32 v145, v82, v83
    v_cvt_pk_bf16_f32 v146, v84, v85
    v_cvt_pk_bf16_f32 v147, v86, v87
    v_pk_fma_f32 v[88:89], v[72:73], v[72:73], v[164:165] neg_lo:[1,0,0] neg_hi:[1,0,0]
    v_pk_fma_f32 v[90:91], v[74:75], v[74:75], v[164:165] neg_lo:[1,0,0] neg_hi:[1,0,0]
    v_pk_fma_f32 v[92:93], v[76:77], v[76:77], v[164:165] neg_lo:[1,0,0] neg_hi:[1,0,0]
    v_pk_fma_f32 v[94:95], v[78:79], v[78:79], v[164:165] neg_lo:[1,0,0] neg_hi:[1,0,0]
    v_pk_mul_f32 v[88:89], v[72:73], v[88:89]
    v_pk_mul_f32 v[90:91], v[74:75], v[90:91]
    v_pk_mul_f32 v[92:93], v[76:77], v[92:93]
    v_pk_mul_f32 v[94:95], v[78:79], v[94:95]
    s_waitcnt lgkmcnt(0)
    v_mfma_f32_16x16x32_bf16 v[64:67], v[16:19], v[40:43], 0
    v_exp_f32 v88, v88
    v_mfma_f32_16x16x32_bf16 v[68:71], v[28:31], v[40:43], 0
    v_exp_f32 v89, v89
    v_mfma_f32_16x16x32_bf16 v[64:67], v[20:23], v[44:47], v[64:67]
    v_exp_f32 v90, v90
    v_exp_f32 v91, v91
    v_exp_f32 v92, v92
    v_exp_f32 v93, v93
    v_exp_f32 v94, v94
    v_exp_f32 v95, v95
    v_pk_add_f32 v[88:89], v[88:89], v[166:167]
    v_pk_add_f32 v[90:91], v[90:91], v[166:167]
    v_pk_add_f32 v[92:93], v[92:93], v[166:167]
    v_pk_add_f32 v[94:95], v[94:95], v[166:167]
    v_mfma_f32_16x16x32_bf16 v[68:71], v[32:35], v[44:47], v[68:71]
    v_rcp_f32 v88, v88
    v_mfma_f32_16x16x32_bf16 v[64:67], v[24:27], v[48:51], v[64:67]
    v_rcp_f32 v89, v89
    v_mfma_f32_16x16x32_bf16 v[68:71], v[36:39], v[48:51], v[68:71]
    v_rcp_f32 v90, v90
    v_rcp_f32 v91, v91
    v_rcp_f32 v92, v92
    v_rcp_f32 v93, v93
    v_rcp_f32 v94, v94
    v_rcp_f32 v95, v95
    v_pk_mul_f32 v[88:89], v[72:73], v[88:89]
    v_pk_mul_f32 v[90:91], v[74:75], v[90:91]
    v_pk_mul_f32 v[92:93], v[76:77], v[92:93]
    v_pk_mul_f32 v[94:95], v[78:79], v[94:95]
    v_pk_fma_f32 v[96:97], v[88:89], v[88:89], v[96:97]
    v_pk_fma_f32 v[98:99], v[90:91], v[90:91], v[98:99]
    v_pk_fma_f32 v[100:101], v[92:93], v[92:93], v[100:101]
    v_pk_fma_f32 v[102:103], v[94:95], v[94:95], v[102:103]
    v_cvt_pk_bf16_f32 v148, v88, v89
    v_cvt_pk_bf16_f32 v149, v90, v91
    v_cvt_pk_bf16_f32 v150, v92, v93
    v_cvt_pk_bf16_f32 v151, v94, v95
    v_pk_fma_f32 v[80:81], v[64:65], v[64:65], v[164:165] neg_lo:[1,0,0] neg_hi:[1,0,0]
    v_pk_fma_f32 v[82:83], v[66:67], v[66:67], v[164:165] neg_lo:[1,0,0] neg_hi:[1,0,0]
    v_pk_fma_f32 v[84:85], v[68:69], v[68:69], v[164:165] neg_lo:[1,0,0] neg_hi:[1,0,0]
    v_pk_fma_f32 v[86:87], v[70:71], v[70:71], v[164:165] neg_lo:[1,0,0] neg_hi:[1,0,0]
    v_pk_mul_f32 v[80:81], v[64:65], v[80:81]
    v_pk_mul_f32 v[82:83], v[66:67], v[82:83]
    v_pk_mul_f32 v[84:85], v[68:69], v[84:85]
    v_pk_mul_f32 v[86:87], v[70:71], v[86:87]
    v_exp_f32 v80, v80
    v_exp_f32 v81, v81
    v_exp_f32 v82, v82
    v_exp_f32 v83, v83
    v_exp_f32 v84, v84
    v_exp_f32 v85, v85
    v_exp_f32 v86, v86
    v_exp_f32 v87, v87
    v_pk_add_f32 v[80:81], v[80:81], v[166:167]
    v_pk_add_f32 v[82:83], v[82:83], v[166:167]
    v_pk_add_f32 v[84:85], v[84:85], v[166:167]
    v_pk_add_f32 v[86:87], v[86:87], v[166:167]
    v_rcp_f32 v80, v80
    v_rcp_f32 v81, v81
    v_rcp_f32 v82, v82
    v_rcp_f32 v83, v83
    v_rcp_f32 v84, v84
    v_rcp_f32 v85, v85
    v_rcp_f32 v86, v86
    v_rcp_f32 v87, v87
    v_pk_mul_f32 v[80:81], v[64:65], v[80:81]
    v_pk_mul_f32 v[82:83], v[66:67], v[82:83]
    v_pk_mul_f32 v[84:85], v[68:69], v[84:85]
    v_pk_mul_f32 v[86:87], v[70:71], v[86:87]
    v_pk_fma_f32 v[96:97], v[80:81], v[80:81], v[96:97]
    v_pk_fma_f32 v[98:99], v[82:83], v[82:83], v[98:99]
    v_pk_fma_f32 v[100:101], v[84:85], v[84:85], v[100:101]
    v_pk_fma_f32 v[102:103], v[86:87], v[86:87], v[102:103]
    v_cvt_pk_bf16_f32 v152, v80, v81
    v_cvt_pk_bf16_f32 v153, v82, v83
    v_cvt_pk_bf16_f32 v154, v84, v85
    v_cvt_pk_bf16_f32 v155, v86, v87
    v_add_f32_dpp v96, v96, v96 row_ror:8 row_mask:0xf bank_mask:0xf
    v_add_f32_dpp v97, v97, v97 row_ror:8 row_mask:0xf bank_mask:0xf
    v_add_f32_dpp v98, v98, v98 row_ror:8 row_mask:0xf bank_mask:0xf
    v_add_f32_dpp v99, v99, v99 row_ror:8 row_mask:0xf bank_mask:0xf
    v_add_f32_dpp v100, v100, v100 row_ror:8 row_mask:0xf bank_mask:0xf
    v_add_f32_dpp v101, v101, v101 row_ror:8 row_mask:0xf bank_mask:0xf
    v_add_f32_dpp v102, v102, v102 row_ror:8 row_mask:0xf bank_mask:0xf
    v_add_f32_dpp v103, v103, v103 row_ror:8 row_mask:0xf bank_mask:0xf
    v_add_f32_dpp v96, v96, v96 row_ror:4 row_mask:0xf bank_mask:0xf
    v_add_f32_dpp v97, v97, v97 row_ror:4 row_mask:0xf bank_mask:0xf
    v_add_f32_dpp v98, v98, v98 row_ror:4 row_mask:0xf bank_mask:0xf
    v_add_f32_dpp v99, v99, v99 row_ror:4 row_mask:0xf bank_mask:0xf
    v_add_f32_dpp v100, v100, v100 row_ror:4 row_mask:0xf bank_mask:0xf
    v_add_f32_dpp v101, v101, v101 row_ror:4 row_mask:0xf bank_mask:0xf
    v_add_f32_dpp v102, v102, v102 row_ror:4 row_mask:0xf bank_mask:0xf
    v_add_f32_dpp v103, v103, v103 row_ror:4 row_mask:0xf bank_mask:0xf
    v_add_f32_dpp v96, v96, v96 row_ror:2 row_mask:0xf bank_mask:0xf
    v_add_f32_dpp v97, v97, v97 row_ror:2 row_mask:0xf bank_mask:0xf
    v_add_f32_dpp v98, v98, v98 row_ror:2 row_mask:0xf bank_mask:0xf
    v_add_f32_dpp v99, v99, v99 row_ror:2 row_mask:0xf bank_mask:0xf
    v_add_f32_dpp v100, v100, v100 row_ror:2 row_mask:0xf bank_mask:0xf
    v_add_f32_dpp v101, v101, v101 row_ror:2 row_mask:0xf bank_mask:0xf
    v_add_f32_dpp v102, v102, v102 row_ror:2 row_mask:0xf bank_mask:0xf
    v_add_f32_dpp v103, v103, v103 row_ror:2 row_mask:0xf bank_mask:0xf
    v_add_f32_dpp v96, v96, v96 row_ror:1 row_mask:0xf bank_mask:0xf
    v_add_f32_dpp v97, v97, v97 row_ror:1 row_mask:0xf bank_mask:0xf
    v_add_f32_dpp v98, v98, v98 row_ror:1 row_mask:0xf bank_mask:0xf
    v_add_f32_dpp v99, v99, v99 row_ror:1 row_mask:0xf bank_mask:0xf
    v_add_f32_dpp v100, v100, v100 row_ror:1 row_mask:0xf bank_mask:0xf
    v_add_f32_dpp v101, v101, v101 row_ror:1 row_mask:0xf bank_mask:0xf
    v_add_f32_dpp v102, v102, v102 row_ror:1 row_mask:0xf bank_mask:0xf
    v_add_f32_dpp v103, v103, v103 row_ror:1 row_mask:0xf bank_mask:0xf
    v_cmp_eq_u32 vcc, 1, v2
    v_lshlrev_b32 v5, 4, v3
    v_lshl_add_u32 v5, v2, 6, v5
    v_cndmask_b32 v96, v96, v100, vcc
    v_cndmask_b32 v97, v97, v101, vcc
    v_cndmask_b32 v98, v98, v102, vcc
    v_cndmask_b32 v99, v99, v103, vcc
    v_or_b32 v96, s47, v96
    v_or_b32 v97, s47, v97
    v_or_b32 v98, s47, v98
    v_or_b32 v99, s47, v99
    s_mul_i32 s43, s2, 1536
    s_lshl_b32 s44, s40, 7
    s_add_u32 s43, s43, s44
    s_mov_b32 exec_lo, 0x00030003
    s_mov_b32 exec_hi, 0x00030003
    buffer_store_dwordx4 v[96:99], v5, s[36:39], s43 offen sc1
    s_mov_b64 exec, -1
    v_bfe_u32 v5, v1, 2, 2
    v_lshl_add_u32 v5, v3, 2, v5
    v_mul_u32_u24 v5, 192, v5
    v_and_b32 v6, 3, v1
    v_lshl_add_u32 v5, v6, 3, v5
    v_and_b32 v6, 1, v3
    v_xor_b32 v6, s77, v6
    v_lshl_add_u32 v5, v6, 5, v5
    v_add_u32 v6, 36864, v5
    ds_read_b64_tr_b16 v[16:17], v5 offset:0
    ds_read_b64_tr_b16 v[18:19], v5 offset:3072
    ds_read_b64_tr_b16 v[20:21], v5 offset:6144
    ds_read_b64_tr_b16 v[22:23], v5 offset:9216
    ds_read_b64_tr_b16 v[24:25], v5 offset:12288
    ds_read_b64_tr_b16 v[26:27], v5 offset:15360
    ds_read_b64_tr_b16 v[28:29], v5 offset:18432
    ds_read_b64_tr_b16 v[30:31], v5 offset:21504
    ds_read_b64_tr_b16 v[32:33], v5 offset:24576
    ds_read_b64_tr_b16 v[34:35], v5 offset:27648
    ds_read_b64_tr_b16 v[36:37], v5 offset:30720
    ds_read_b64_tr_b16 v[38:39], v5 offset:33792
    ds_read_b64_tr_b16 v[40:41], v6 offset:0
    ds_read_b64_tr_b16 v[42:43], v6 offset:3072
    ds_read_b64_tr_b16 v[44:45], v6 offset:6144
    ds_read_b64_tr_b16 v[46:47], v6 offset:9216
    ds_read_b64_tr_b16 v[48:49], v6 offset:12288
    ds_read_b64_tr_b16 v[50:51], v6 offset:15360
    ds_read_b64_tr_b16 v[52:53], v6 offset:18432
    ds_read_b64_tr_b16 v[54:55], v6 offset:21504
    ds_read_b64_tr_b16 v[56:57], v6 offset:24576
    ds_read_b64_tr_b16 v[58:59], v6 offset:27648
    ds_read_b64_tr_b16 v[60:61], v6 offset:30720
    ds_read_b64_tr_b16 v[62:63], v6 offset:33792
    s_lshl_b32 s43, s40, 10
    v_add_u32 v5, s43, v4
    v_add_u32 v6, 61440, v5
    v_add_u32 v7, 122880, v5
    v_lshl_add_u32 v8, v3, 2, v2
    v_lshlrev_b32 v8, 4, v8
    s_lshl_b32 s43, s40, 8
    s_add_u32 s43, s43, 147456
    v_add_u32 v8, s43, v8
    ds_write_b128 v6, v[128:131] offset:12288
    ds_write_b128 v6, v[132:135] offset:24576
    ds_write_b128 v6, v[136:139] offset:36864
    ds_write_b128 v6, v[140:143] offset:49152
    ds_write_b128 v7, v[144:147] offset:0
    ds_write_b128 v7, v[148:151] offset:12288
    s_waitcnt lgkmcnt(6)
    s_barrier
    ds_write_b128 v5, v[104:107] offset:0
    ds_write_b128 v5, v[108:111] offset:12288
    ds_write_b128 v5, v[112:115] offset:24576
    ds_write_b128 v5, v[116:119] offset:36864
    ds_write_b128 v5, v[120:123] offset:49152
    ds_write_b128 v6, v[124:127] offset:0
    s_mov_b32 exec_lo, 0x000f000f
    s_mov_b32 exec_hi, 0x000f000f
    ds_write_b128 v8, v[152:155]
    s_mov_b64 exec, -1
    s_cmp_ge_u32 s2, 12
    s_cbranch_scc1 L_nored
    s_sub_u32 s43, s40, 2
    s_cmp_ge_u32 s43, 8
    s_cbranch_scc1 L_rb
    v_lshrrev_b32 v9, 3, v1
    v_mul_u32_u24 v9, 1536, v9
    v_and_b32 v10, 7, v1
    v_lshlrev_b32 v10, 4, v10
    v_add_u32 v9, v9, v10
    s_mul_i32 s44, s43, 49152
    s_lshl_b32 s45, s2, 7
    s_add_u32 s44, s44, s45
    v_add_u32 v9, s44, v9
    s_lshl_b32 s43, s43, 7
    s_add_u32 s43, s43, 160512
    v_add_u32 v10, s43, v10
    s_mov_b32 s76, 131072
L_p1:
    buffer_load_dwordx4 v[64:67], v9, s[36:39], s68 offen sc1
    buffer_load_dwordx4 v[68:71], v9, s[36:39], s69 offen sc1
    buffer_load_dwordx4 v[72:75], v9, s[36:39], s70 offen sc1
    buffer_load_dwordx4 v[76:79], v9, s[36:39], s71 offen sc1
    s_waitcnt vmcnt(0)
    v_and_b32 v80, v64, v65
    v_and_b32 v80, v80, v66
    v_and_b32 v80, v80, v67
    v_and_b32 v80, v80, v68
    v_and_b32 v80, v80, v69
    v_and_b32 v80, v80, v70
    v_and_b32 v80, v80, v71
    v_and_b32 v80, v80, v72
    v_and_b32 v80, v80, v73
    v_and_b32 v80, v80, v74
    v_and_b32 v80, v80, v75
    v_and_b32 v80, v80, v76
    v_and_b32 v80, v80, v77
    v_and_b32 v80, v80, v78
    v_and_b32 v80, v80, v79
    v_cmp_le_i32 vcc, 0, v80
    s_nop 1
    s_mov_b64 exec, vcc
    s_cbranch_execz L_p1d
    s_sub_u32 s76, s76, 1
    s_cmp_eq_u32 s76, 0
    s_cbranch_scc0 L_p1
L_p1d:
    s_mov_b64 exec, -1
    v_add_f32 v64, abs(v64), abs(v68)
    v_add_f32 v72, abs(v72), abs(v76)
    v_add_f32 v65, abs(v65), abs(v69)
    v_add_f32 v73, abs(v73), abs(v77)
    v_add_f32 v66, abs(v66), abs(v70)
    v_add_f32 v74, abs(v74), abs(v78)
    v_add_f32 v67, abs(v67), abs(v71)
    v_add_f32 v75, abs(v75), abs(v79)
    v_add_f32 v64, v64, v72
    v_add_f32 v65, v65, v73
    v_add_f32 v66, v66, v74
    v_add_f32 v67, v67, v75
    s_nop 1
    v_add_f32_dpp v64, v64, v64 row_ror:8 row_mask:0xf bank_mask:0xf
    v_add_f32_dpp v65, v65, v65 row_ror:8 row_mask:0xf bank_mask:0xf
    v_add_f32_dpp v66, v66, v66 row_ror:8 row_mask:0xf bank_mask:0xf
    v_add_f32_dpp v67, v67, v67 row_ror:8 row_mask:0xf bank_mask:0xf
    v_mov_b32 v68, v64
    v_mov_b32 v69, v65
    v_mov_b32 v70, v66
    v_mov_b32 v71, v67
    s_nop 1
    v_permlane16_swap_b32 v64, v68
    v_permlane16_swap_b32 v65, v69
    v_permlane16_swap_b32 v66, v70
    v_permlane16_swap_b32 v67, v71
    s_nop 1
    v_add_f32 v64, v64, v68
    v_add_f32 v65, v65, v69
    v_add_f32 v66, v66, v70
    v_add_f32 v67, v67, v71
    v_mov_b32 v68, v64
    v_mov_b32 v69, v65
    v_mov_b32 v70, v66
    v_mov_b32 v71, v67
    s_nop 1
    v_permlane32_swap_b32 v64, v68
    v_permlane32_swap_b32 v65, v69
    v_permlane32_swap_b32 v66, v70
    v_permlane32_swap_b32 v67, v71
    s_nop 1
    v_add_f32 v64, v64, v68
    v_add_f32 v65, v65, v69
    v_add_f32 v66, v66, v70
    v_add_f32 v67, v67, v71
    s_mov_b64 exec, 0xff
    ds_write_b128 v10, v[64:67]
    s_mov_b64 exec, -1
    s_waitcnt lgkmcnt(0)
L_rb:
    s_barrier
    s_cmp_eq_u32 s40, 2
    s_cbranch_scc0 L_nored
    v_add_u32 v9, 160512, v4
    ds_read_b128 v[64:67], v9
    s_lshl_b32 s43, s2, 7
    s_add_u32 s43, s43, 393216
    s_waitcnt lgkmcnt(0)
    v_add_f32_dpp v64, v64, v64 row_ror:8 row_mask:0xf bank_mask:0xf
    v_add_f32_dpp v65, v65, v65 row_ror:8 row_mask:0xf bank_mask:0xf
    v_add_f32_dpp v66, v66, v66 row_ror:8 row_mask:0xf bank_mask:0xf
    v_add_f32_dpp v67, v67, v67 row_ror:8 row_mask:0xf bank_mask:0xf
    v_mov_b32 v68, v64
    v_mov_b32 v69, v65
    v_mov_b32 v70, v66
    v_mov_b32 v71, v67
    s_nop 1
    v_permlane16_swap_b32 v64, v68
    v_permlane16_swap_b32 v65, v69
    v_permlane16_swap_b32 v66, v70
    v_permlane16_swap_b32 v67, v71
    s_nop 1
    v_add_f32 v64, v64, v68
    v_add_f32 v65, v65, v69
    v_add_f32 v66, v66, v70
    v_add_f32 v67, v67, v71
    v_mov_b32 v68, v64
    v_mov_b32 v69, v65
    v_mov_b32 v70, v66
    v_mov_b32 v71, v67
    s_nop 1
    v_permlane32_swap_b32 v64, v68
    v_permlane32_swap_b32 v65, v69
    v_permlane32_swap_b32 v66, v70
    v_permlane32_swap_b32 v67, v71
    s_nop 1
    v_add_f32 v64, v64, v68
    v_add_f32 v65, v65, v69
    v_add_f32 v66, v66, v70
    v_add_f32 v67, v67, v71
    v_or_b32 v64, s47, v64
    v_or_b32 v65, s47, v65
    v_or_b32 v66, s47, v66
    v_or_b32 v67, s47, v67
    s_mov_b64 exec, 0xff
    buffer_store_dwordx4 v[64:67], v4, s[36:39], s43 offen sc1
    s_mov_b64 exec, -1
L_nored:
    v_lshlrev_b32 v5, 3, v3
    v_add_u32 v5, 159744, v5
    ds_read2_b64 v[64:67], v5 offset0:0 offset1:4
    ds_read2_b64 v[68:71], v5 offset0:8 offset1:12
    ds_read2_b64 v[72:75], v5 offset0:16 offset1:20
    ds_read2_b64 v[76:79], v5 offset0:24 offset1:28
    ds_read2_b64 v[80:83], v5 offset0:32 offset1:36
    ds_read2_b64 v[84:87], v5 offset0:40 offset1:44
    ds_read2_b64 v[88:91], v5 offset0:48 offset1:52
    ds_read2_b64 v[92:95], v5 offset0:56 offset1:60
    ds_read2_b64 v[96:99], v5 offset0:64 offset1:68
    ds_read2_b64 v[100:103], v5 offset0:72 offset1:76
    ds_read2_b64 v[104:107], v5 offset0:80 offset1:84
    ds_read2_b64 v[108:111], v5 offset0:88 offset1:92
    s_mul_i32 s43, s78, 86016
    v_add_u32 v9, s43, v4
    v_add_u32 v10, 49152, v9
    v_min_u32 v11, 3, v2
    v_lshl_add_u32 v11, v3, 2, v11
    v_lshlrev_b32 v11, 4, v11
    v_add_u32 v11, 147456, v11
    v_min_u32 v12, 11, v2
    v_lshlrev_b32 v12, 7, v12
    v_lshl_add_u32 v12, v3, 4, v12
    v_add_u32 v12, 158208, v12
    v_mov_b32 v2, v156
    v_mov_b32 v3, v157
    v_mov_b32 v4, v158
    v_mov_b32 v5, v159
    v_mov_b32 v6, v160
    v_mov_b32 v7, v161
    v_mov_b32 v8, v162
    s_waitcnt lgkmcnt(0)
    v_mfma_f32_16x16x32_bf16 v[164:167], v[16:19], v[64:67], 0
    v_mfma_f32_16x16x32_bf16 v[164:167], v[20:23], v[68:71], v[164:167]
    v_mfma_f32_16x16x32_bf16 v[164:167], v[24:27], v[72:75], v[164:167]
    v_mfma_f32_16x16x32_bf16 v[164:167], v[28:31], v[76:79], v[164:167]
    v_mfma_f32_16x16x32_bf16 v[164:167], v[32:35], v[80:83], v[164:167]
    v_mfma_f32_16x16x32_bf16 v[164:167], v[36:39], v[84:87], v[164:167]
    v_mfma_f32_16x16x32_bf16 v[164:167], v[40:43], v[88:91], v[164:167]
    v_mfma_f32_16x16x32_bf16 v[164:167], v[44:47], v[92:95], v[164:167]
    v_mfma_f32_16x16x32_bf16 v[164:167], v[48:51], v[96:99], v[164:167]
    v_mfma_f32_16x16x32_bf16 v[164:167], v[52:55], v[100:103], v[164:167]
    v_mfma_f32_16x16x32_bf16 v[164:167], v[56:59], v[104:107], v[164:167]
    v_mfma_f32_16x16x32_bf16 v[164:167], v[60:63], v[108:111], v[164:167]
    s_mov_b32 s46, 0xffff0000
    v_mov_b32 v15, s46
    s_nop 7
    v_lshlrev_b32 v64, 16, v16
    v_and_b32 v65, v15, v16
    v_lshlrev_b32 v66, 16, v17
    v_and_b32 v67, v15, v17
    v_lshlrev_b32 v68, 16, v18
    v_and_b32 v69, v15, v18
    v_lshlrev_b32 v70, 16, v19
    v_and_b32 v71, v15, v19
    v_lshlrev_b32 v72, 16, v20
    v_and_b32 v73, v15, v20
    v_lshlrev_b32 v74, 16, v21
    v_and_b32 v75, v15, v21
    v_lshlrev_b32 v76, 16, v22
    v_and_b32 v77, v15, v22
    v_lshlrev_b32 v78, 16, v23
    v_and_b32 v79, v15, v23
    v_lshlrev_b32 v80, 16, v24
    v_and_b32 v81, v15, v24
    v_lshlrev_b32 v82, 16, v25
    v_and_b32 v83, v15, v25
    v_lshlrev_b32 v84, 16, v26
    v_and_b32 v85, v15, v26
    v_lshlrev_b32 v86, 16, v27
    v_and_b32 v87, v15, v27
    v_lshlrev_b32 v88, 16, v28
    v_and_b32 v89, v15, v28
    v_lshlrev_b32 v90, 16, v29
    v_and_b32 v91, v15, v29
    v_lshlrev_b32 v92, 16, v30
    v_and_b32 v93, v15, v30
    v_lshlrev_b32 v94, 16, v31
    v_and_b32 v95, v15, v31
    v_lshlrev_b32 v96, 16, v32
    v_and_b32 v97, v15, v32
    v_lshlrev_b32 v98, 16, v33
    v_and_b32 v99, v15, v33
    v_lshlrev_b32 v100, 16, v34
    v_and_b32 v101, v15, v34
    v_lshlrev_b32 v102, 16, v35
    v_and_b32 v103, v15, v35
    v_lshlrev_b32 v104, 16, v36
    v_and_b32 v105, v15, v36
    v_lshlrev_b32 v106, 16, v37
    v_and_b32 v107, v15, v37
    v_lshlrev_b32 v108, 16, v38
    v_and_b32 v109, v15, v38
    v_lshlrev_b32 v110, 16, v39
    v_and_b32 v111, v15, v39
    v_lshlrev_b32 v112, 16, v40
    v_and_b32 v113, v15, v40
    v_lshlrev_b32 v114, 16, v41
    v_and_b32 v115, v15, v41
    v_lshlrev_b32 v116, 16, v42
    v_and_b32 v117, v15, v42
    v_lshlrev_b32 v118, 16, v43
    v_and_b32 v119, v15, v43
    v_lshlrev_b32 v120, 16, v44
    v_and_b32 v121, v15, v44
    v_lshlrev_b32 v122, 16, v45
    v_and_b32 v123, v15, v45
    v_lshlrev_b32 v124, 16, v46
    v_and_b32 v125, v15, v46
    v_lshlrev_b32 v126, 16, v47
    v_and_b32 v127, v15, v47
    v_lshlrev_b32 v128, 16, v48
    v_and_b32 v129, v15, v48
    v_lshlrev_b32 v130, 16, v49
    v_and_b32 v131, v15, v49
    v_lshlrev_b32 v132, 16, v50
    v_and_b32 v133, v15, v50
    v_lshlrev_b32 v134, 16, v51
    v_and_b32 v135, v15, v51
    v_lshlrev_b32 v136, 16, v52
    v_and_b32 v137, v15, v52
    v_lshlrev_b32 v138, 16, v53
    v_and_b32 v139, v15, v53
    v_lshlrev_b32 v140, 16, v54
    v_and_b32 v141, v15, v54
    v_lshlrev_b32 v142, 16, v55
    v_and_b32 v143, v15, v55
    v_lshlrev_b32 v144, 16, v56
    v_and_b32 v145, v15, v56
    v_lshlrev_b32 v146, 16, v57
    v_and_b32 v147, v15, v57
    v_lshlrev_b32 v148, 16, v58
    v_and_b32 v149, v15, v58
    v_lshlrev_b32 v150, 16, v59
    v_and_b32 v151, v15, v59
    v_lshlrev_b32 v152, 16, v60
    v_and_b32 v153, v15, v60
    v_lshlrev_b32 v154, 16, v61
    v_and_b32 v155, v15, v61
    v_lshlrev_b32 v156, 16, v62
    v_and_b32 v157, v15, v62
    v_lshlrev_b32 v158, 16, v63
    v_and_b32 v159, v15, v63
    buffer_load_dwordx2 v[44:45], v2, s[4:7], 0 offen
    buffer_load_dwordx2 v[46:47], v3, s[4:7], 0 offen
    buffer_load_dwordx2 v[48:49], v4, s[4:7], 0 offen
    buffer_load_dwordx2 v[50:51], v5, s[4:7], 0 offen
    buffer_load_dwordx2 v[52:53], v6, s[4:7], 0 offen
    buffer_load_dwordx2 v[54:55], v7, s[4:7], 0 offen
    buffer_load_dwordx2 v[56:57], v8, s[4:7], 0 offen
    s_cmp_eq_u32 s40, 1
    s_cbranch_scc0 L_ng
    v_lshlrev_b32 v13, 3, v1
    v_lshlrev_b32 v14, 2, v1
    buffer_load_dwordx2 v[58:59], v13, s[20:23], 0 offen
    buffer_load_dword v60, v14, s[20:23], 0 offen offset:512
L_ng:
    s_waitcnt vmcnt(0)
    v_lshlrev_b32 v16, 16, v44
    v_and_b32 v17, s46, v44
    v_lshlrev_b32 v18, 16, v45
    v_and_b32 v19, s46, v45
    v_pk_add_f32 v[16:17], v[16:17], v[164:165]
    v_pk_add_f32 v[18:19], v[18:19], v[166:167]
    v_lshlrev_b32 v20, 16, v46
    v_and_b32 v21, s46, v46
    v_lshlrev_b32 v22, 16, v47
    v_and_b32 v23, s46, v47
    v_pk_add_f32 v[20:21], v[20:21], v[164:165]
    v_pk_add_f32 v[22:23], v[22:23], v[166:167]
    v_lshlrev_b32 v24, 16, v48
    v_and_b32 v25, s46, v48
    v_lshlrev_b32 v26, 16, v49
    v_and_b32 v27, s46, v49
    v_pk_add_f32 v[24:25], v[24:25], v[164:165]
    v_pk_add_f32 v[26:27], v[26:27], v[166:167]
    v_lshlrev_b32 v28, 16, v50
    v_and_b32 v29, s46, v50
    v_lshlrev_b32 v30, 16, v51
    v_and_b32 v31, s46, v51
    v_pk_add_f32 v[28:29], v[28:29], v[164:165]
    v_pk_add_f32 v[30:31], v[30:31], v[166:167]
    v_lshlrev_b32 v32, 16, v52
    v_and_b32 v33, s46, v52
    v_lshlrev_b32 v34, 16, v53
    v_and_b32 v35, s46, v53
    v_pk_add_f32 v[32:33], v[32:33], v[164:165]
    v_pk_add_f32 v[34:35], v[34:35], v[166:167]
    v_lshlrev_b32 v36, 16, v54
    v_and_b32 v37, s46, v54
    v_lshlrev_b32 v38, 16, v55
    v_and_b32 v39, s46, v55
    v_pk_add_f32 v[36:37], v[36:37], v[164:165]
    v_pk_add_f32 v[38:39], v[38:39], v[166:167]
    v_lshlrev_b32 v40, 16, v56
    v_and_b32 v41, s46, v56
    v_lshlrev_b32 v42, 16, v57
    v_and_b32 v43, s46, v57
    v_pk_add_f32 v[40:41], v[40:41], v[164:165]
    v_pk_add_f32 v[42:43], v[42:43], v[166:167]
    s_cmp_eq_u32 s40, 1
    s_cbranch_scc0 L_nos
    v_lshlrev_b32 v14, 4, v1
    s_mov_b32 s43, 393216
    s_mov_b32 s76, 131072
L_p2:
    buffer_load_dwordx4 v[44:47], v14, s[36:39], s43 offen sc1
    buffer_load_dwordx2 v[48:49], v13, s[36:39], s43 offen offset:1024 sc1
    s_waitcnt vmcnt(0)
    v_and_b32 v50, v44, v45
    v_and_b32 v50, v50, v46
    v_and_b32 v50, v50, v47
    v_and_b32 v50, v50, v48
    v_and_b32 v50, v50, v49
    v_cmp_le_i32 vcc, 0, v50
    s_nop 1
    s_mov_b64 exec, vcc
    s_cbranch_execz L_p2d
    s_sub_u32 s76, s76, 1
    s_cmp_eq_u32 s76, 0
    s_cbranch_scc0 L_p2
L_p2d:
    s_mov_b64 exec, -1
    v_mov_b32 v50, 0x358637bd
    v_mov_b32 v51, 0x4091afa4
    v_fma_f32 v44, abs(v44), v51, v50
    v_fma_f32 v45, abs(v45), v51, v50
    v_fma_f32 v46, abs(v46), v51, v50
    v_fma_f32 v47, abs(v47), v51, v50
    v_fma_f32 v48, abs(v48), v51, v50
    v_fma_f32 v49, abs(v49), v51, v50
    v_sqrt_f32 v44, v44
    v_sqrt_f32 v45, v45
    v_sqrt_f32 v46, v46
    v_sqrt_f32 v47, v47
    v_sqrt_f32 v48, v48
    v_sqrt_f32 v49, v49
    s_nop 0
    v_add_f32 v51, v44, v45
    v_add_f32 v52, v46, v47
    v_add_f32 v53, v48, v49
    v_add_f32 v51, v51, v52
    v_add_f32 v51, v51, v53
    s_nop 1
    v_add_f32_dpp v51, v51, v51 row_ror:8 row_mask:0xf bank_mask:0xf
    s_nop 1
    v_add_f32_dpp v51, v51, v51 row_ror:4 row_mask:0xf bank_mask:0xf
    s_nop 1
    v_add_f32_dpp v51, v51, v51 row_ror:2 row_mask:0xf bank_mask:0xf
    s_nop 1
    v_add_f32_dpp v51, v51, v51 row_ror:1 row_mask:0xf bank_mask:0xf
    s_nop 1
    v_mov_b32 v52, v51
    s_nop 1
    v_permlane16_swap_b32 v51, v52
    s_nop 1
    v_add_f32 v51, v51, v52
    v_mov_b32 v52, v51
    s_nop 1
    v_permlane32_swap_b32 v51, v52
    s_nop 1
    v_add_f32 v51, v51, v52
    v_mov_b32 v52, 0x3b2aaaab
    v_fma_f32 v51, v51, v52, v50
    v_rcp_f32 v51, v51
    v_lshlrev_b32 v52, 16, v58
    v_and_b32 v53, s46, v58
    v_lshlrev_b32 v54, 16, v59
    v_and_b32 v55, s46, v59
    v_lshlrev_b32 v56, 16, v60
    v_and_b32 v57, s46, v60
    v_mov_b32 v50, 0x40088e99
    v_mul_f32 v51, v51, v50
    v_mul_f32 v44, v44, v51
    v_mul_f32 v45, v45, v51
    v_mul_f32 v46, v46, v51
    v_mul_f32 v47, v47, v51
    v_mul_f32 v48, v48, v51
    v_mul_f32 v49, v49, v51
    v_fma_f32 v44, v44, v52, v50
    v_fma_f32 v45, v45, v53, v50
    v_fma_f32 v46, v46, v54, v50
    v_fma_f32 v47, v47, v55, v50
    v_fma_f32 v48, v48, v56, v50
    v_fma_f32 v49, v49, v57, v50
    v_add_u32 v14, 158208, v14
    v_add_u32 v13, 159232, v13
    ds_write_b128 v14, v[44:47]
    ds_write_b64 v13, v[48:49]
L_nos:
    s_waitcnt lgkmcnt(0)
    s_barrier
    s_cmp_eq_u32 s78, 0
    s_cbranch_scc0 L_g2b
    ds_read_b128 v[160:163], v12
    ds_read_b128 v[164:167], v12 offset:64
    ds_read_b128 v[44:47], v9 offset:0
    ds_read_b128 v[48:51], v9 offset:12288
    ds_read_b128 v[52:55], v9 offset:24576
    ds_read_b128 v[56:59], v9 offset:36864
    ds_read_b128 v[60:63], v10 offset:0
    s_waitcnt lgkmcnt(5)
    v_mul_f32_dpp v64, v160, v64 row_newbcast:0 row_mask:0xf bank_mask:0xf
    v_mul_f32_dpp v65, v161, v65 row_newbcast:0 row_mask:0xf bank_mask:0xf
    v_mul_f32_dpp v66, v162, v66 row_newbcast:0 row_mask:0xf bank_mask:0xf
    v_mul_f32_dpp v67, v163, v67 row_newbcast:0 row_mask:0xf bank_mask:0xf
    v_mul_f32_dpp v68, v164, v68 row_newbcast:0 row_mask:0xf bank_mask:0xf
    v_mul_f32_dpp v69, v165, v69 row_newbcast:0 row_mask:0xf bank_mask:0xf
    v_mul_f32_dpp v70, v166, v70 row_newbcast:0 row_mask:0xf bank_mask:0xf
    v_mul_f32_dpp v71, v167, v71 row_newbcast:0 row_mask:0xf bank_mask:0xf
    v_cvt_pk_bf16_f32 v64, v64, v65
    v_cvt_pk_bf16_f32 v65, v66, v67
    v_cvt_pk_bf16_f32 v66, v68, v69
    v_cvt_pk_bf16_f32 v67, v70, v71
    s_nop 1
    s_waitcnt lgkmcnt(4)
    v_mfma_f32_16x16x32_bf16 v[16:19], v[64:67], v[44:47], v[16:19]
    ds_read_b128 v[44:47], v10 offset:12288
    v_mul_f32_dpp v72, v160, v72 row_newbcast:1 row_mask:0xf bank_mask:0xf
    v_mul_f32_dpp v73, v161, v73 row_newbcast:1 row_mask:0xf bank_mask:0xf
    v_mul_f32_dpp v74, v162, v74 row_newbcast:1 row_mask:0xf bank_mask:0xf
    s_waitcnt lgkmcnt(4)
    v_mfma_f32_16x16x32_bf16 v[20:23], v[64:67], v[48:51], v[20:23]
    ds_read_b128 v[48:51], v10 offset:24576
    v_mul_f32_dpp v75, v163, v75 row_newbcast:1 row_mask:0xf bank_mask:0xf
    v_mul_f32_dpp v76, v164, v76 row_newbcast:1 row_mask:0xf bank_mask:0xf
    v_mul_f32_dpp v77, v165, v77 row_newbcast:1 row_mask:0xf bank_mask:0xf
    s_waitcnt lgkmcnt(4)
    v_mfma_f32_16x16x32_bf16 v[24:27], v[64:67], v[52:55], v[24:27]
    ds_read_b128 v[52:55], v9 offset:1024
    v_mul_f32_dpp v78, v166, v78 row_newbcast:1 row_mask:0xf bank_mask:0xf
    v_mul_f32_dpp v79, v167, v79 row_newbcast:1 row_mask:0xf bank_mask:0xf
    s_waitcnt lgkmcnt(4)
    v_mfma_f32_16x16x32_bf16 v[28:31], v[64:67], v[56:59], v[28:31]
    ds_read_b128 v[56:59], v9 offset:13312
    v_cvt_pk_bf16_f32 v72, v72, v73
    v_cvt_pk_bf16_f32 v73, v74, v75
    s_waitcnt lgkmcnt(4)
    v_mfma_f32_16x16x32_bf16 v[32:35], v[64:67], v[60:63], v[32:35]
    ds_read_b128 v[60:63], v9 offset:25600
    v_cvt_pk_bf16_f32 v74, v76, v77
    v_cvt_pk_bf16_f32 v75, v78, v79
    s_waitcnt lgkmcnt(4)
    v_mfma_f32_16x16x32_bf16 v[36:39], v[64:67], v[44:47], v[36:39]
    ds_read_b128 v[44:47], v9 offset:37888
    s_waitcnt lgkmcnt(4)
    v_mfma_f32_16x16x32_bf16 v[40:43], v[64:67], v[48:51], v[40:43]
    ds_read_b128 v[48:51], v10 offset:1024
    s_waitcnt lgkmcnt(4)
    v_mfma_f32_16x16x32_bf16 v[16:19], v[72:75], v[52:55], v[16:19]
    ds_read_b128 v[52:55], v10 offset:13312
    v_mul_f32_dpp v80, v160, v80 row_newbcast:2 row_mask:0xf bank_mask:0xf
    v_mul_f32_dpp v81, v161, v81 row_newbcast:2 row_mask:0xf bank_mask:0xf
    v_mul_f32_dpp v82, v162, v82 row_newbcast:2 row_mask:0xf bank_mask:0xf
    s_waitcnt lgkmcnt(4)
    v_mfma_f32_16x16x32_bf16 v[20:23], v[72:75], v[56:59], v[20:23]
    ds_read_b128 v[56:59], v10 offset:25600
    v_mul_f32_dpp v83, v163, v83 row_newbcast:2 row_mask:0xf bank_mask:0xf
    v_mul_f32_dpp v84, v164, v84 row_newbcast:2 row_mask:0xf bank_mask:0xf
    v_mul_f32_dpp v85, v165, v85 row_newbcast:2 row_mask:0xf bank_mask:0xf
    s_waitcnt lgkmcnt(4)
    v_mfma_f32_16x16x32_bf16 v[24:27], v[72:75], v[60:63], v[24:27]
    ds_read_b128 v[60:63], v9 offset:2048
    v_mul_f32_dpp v86, v166, v86 row_newbcast:2 row_mask:0xf bank_mask:0xf
    v_mul_f32_dpp v87, v167, v87 row_newbcast:2 row_mask:0xf bank_mask:0xf
    s_waitcnt lgkmcnt(4)
    v_mfma_f32_16x16x32_bf16 v[28:31], v[72:75], v[44:47], v[28:31]
    ds_read_b128 v[44:47], v9 offset:14336
    v_cvt_pk_bf16_f32 v80, v80, v81
    v_cvt_pk_bf16_f32 v81, v82, v83
    s_waitcnt lgkmcnt(4)
    v_mfma_f32_16x16x32_bf16 v[32:35], v[72:75], v[48:51], v[32:35]
    ds_read_b128 v[48:51], v9 offset:26624
    v_cvt_pk_bf16_f32 v82, v84, v85
    v_cvt_pk_bf16_f32 v83, v86, v87
    s_waitcnt lgkmcnt(4)
    v_mfma_f32_16x16x32_bf16 v[36:39], v[72:75], v[52:55], v[36:39]
    ds_read_b128 v[52:55], v9 offset:38912
    s_waitcnt lgkmcnt(4)
    v_mfma_f32_16x16x32_bf16 v[40:43], v[72:75], v[56:59], v[40:43]
    ds_read_b128 v[56:59], v10 offset:2048
    s_waitcnt lgkmcnt(4)
    v_mfma_f32_16x16x32_bf16 v[16:19], v[80:83], v[60:63], v[16:19]
    ds_read_b128 v[60:63], v10 offset:14336
    v_mul_f32_dpp v88, v160, v88 row_newbcast:3 row_mask:0xf bank_mask:0xf
    v_mul_f32_dpp v89, v161, v89 row_newbcast:3 row_mask:0xf bank_mask:0xf
    v_mul_f32_dpp v90, v162, v90 row_newbcast:3 row_mask:0xf bank_mask:0xf
    s_waitcnt lgkmcnt(4)
    v_mfma_f32_16x16x32_bf16 v[20:23], v[80:83], v[44:47], v[20:23]
    ds_read_b128 v[44:47], v10 offset:26624
    v_mul_f32_dpp v91, v163, v91 row_newbcast:3 row_mask:0xf bank_mask:0xf
    v_mul_f32_dpp v92, v164, v92 row_newbcast:3 row_mask:0xf bank_mask:0xf
    v_mul_f32_dpp v93, v165, v93 row_newbcast:3 row_mask:0xf bank_mask:0xf
    s_waitcnt lgkmcnt(4)
    v_mfma_f32_16x16x32_bf16 v[24:27], v[80:83], v[48:51], v[24:27]
    ds_read_b128 v[48:51], v9 offset:3072
    v_mul_f32_dpp v94, v166, v94 row_newbcast:3 row_mask:0xf bank_mask:0xf
    v_mul_f32_dpp v95, v167, v95 row_newbcast:3 row_mask:0xf bank_mask:0xf
    s_waitcnt lgkmcnt(4)
    v_mfma_f32_16x16x32_bf16 v[28:31], v[80:83], v[52:55], v[28:31]
    ds_read_b128 v[52:55], v9 offset:15360
    v_cvt_pk_bf16_f32 v88, v88, v89
    v_cvt_pk_bf16_f32 v89, v90, v91
    s_waitcnt lgkmcnt(4)
    v_mfma_f32_16x16x32_bf16 v[32:35], v[80:83], v[56:59], v[32:35]
    ds_read_b128 v[56:59], v9 offset:27648
    v_cvt_pk_bf16_f32 v90, v92, v93
    v_cvt_pk_bf16_f32 v91, v94, v95
    s_waitcnt lgkmcnt(4)
    v_mfma_f32_16x16x32_bf16 v[36:39], v[80:83], v[60:63], v[36:39]
    ds_read_b128 v[60:63], v9 offset:39936
    s_waitcnt lgkmcnt(4)
    v_mfma_f32_16x16x32_bf16 v[40:43], v[80:83], v[44:47], v[40:43]
    ds_read_b128 v[44:47], v10 offset:3072
    s_waitcnt lgkmcnt(4)
    v_mfma_f32_16x16x32_bf16 v[16:19], v[88:91], v[48:51], v[16:19]
    ds_read_b128 v[48:51], v10 offset:15360
    v_mul_f32_dpp v96, v160, v96 row_newbcast:4 row_mask:0xf bank_mask:0xf
    v_mul_f32_dpp v97, v161, v97 row_newbcast:4 row_mask:0xf bank_mask:0xf
    v_mul_f32_dpp v98, v162, v98 row_newbcast:4 row_mask:0xf bank_mask:0xf
    s_waitcnt lgkmcnt(4)
    v_mfma_f32_16x16x32_bf16 v[20:23], v[88:91], v[52:55], v[20:23]
    ds_read_b128 v[52:55], v10 offset:27648
    v_mul_f32_dpp v99, v163, v99 row_newbcast:4 row_mask:0xf bank_mask:0xf
    v_mul_f32_dpp v100, v164, v100 row_newbcast:4 row_mask:0xf bank_mask:0xf
    v_mul_f32_dpp v101, v165, v101 row_newbcast:4 row_mask:0xf bank_mask:0xf
    s_waitcnt lgkmcnt(4)
    v_mfma_f32_16x16x32_bf16 v[24:27], v[88:91], v[56:59], v[24:27]
    ds_read_b128 v[56:59], v9 offset:4096
    v_mul_f32_dpp v102, v166, v102 row_newbcast:4 row_mask:0xf bank_mask:0xf
    v_mul_f32_dpp v103, v167, v103 row_newbcast:4 row_mask:0xf bank_mask:0xf
    s_waitcnt lgkmcnt(4)
    v_mfma_f32_16x16x32_bf16 v[28:31], v[88:91], v[60:63], v[28:31]
    ds_read_b128 v[60:63], v9 offset:16384
    v_cvt_pk_bf16_f32 v96, v96, v97
    v_cvt_pk_bf16_f32 v97, v98, v99
    s_waitcnt lgkmcnt(4)
    v_mfma_f32_16x16x32_bf16 v[32:35], v[88:91], v[44:47], v[32:35]
    ds_read_b128 v[44:47], v9 offset:28672
    v_cvt_pk_bf16_f32 v98, v100, v101
    v_cvt_pk_bf16_f32 v99, v102, v103
    s_waitcnt lgkmcnt(4)
    v_mfma_f32_16x16x32_bf16 v[36:39], v[88:91], v[48:51], v[36:39]
    ds_read_b128 v[48:51], v9 offset:40960
    s_waitcnt lgkmcnt(4)
    v_mfma_f32_16x16x32_bf16 v[40:43], v[88:91], v[52:55], v[40:43]
    ds_read_b128 v[52:55], v10 offset:4096
    s_waitcnt lgkmcnt(4)
    v_mfma_f32_16x16x32_bf16 v[16:19], v[96:99], v[56:59], v[16:19]
    ds_read_b128 v[56:59], v10 offset:16384
    v_mul_f32_dpp v104, v160, v104 row_newbcast:5 row_mask:0xf bank_mask:0xf
    v_mul_f32_dpp v105, v161, v105 row_newbcast:5 row_mask:0xf bank_mask:0xf
    v_mul_f32_dpp v106, v162, v106 row_newbcast:5 row_mask:0xf bank_mask:0xf
    s_waitcnt lgkmcnt(4)
    v_mfma_f32_16x16x32_bf16 v[20:23], v[96:99], v[60:63], v[20:23]
    ds_read_b128 v[60:63], v10 offset:28672
    v_mul_f32_dpp v107, v163, v107 row_newbcast:5 row_mask:0xf bank_mask:0xf
    v_mul_f32_dpp v108, v164, v108 row_newbcast:5 row_mask:0xf bank_mask:0xf
    v_mul_f32_dpp v109, v165, v109 row_newbcast:5 row_mask:0xf bank_mask:0xf
    s_waitcnt lgkmcnt(4)
    v_mfma_f32_16x16x32_bf16 v[24:27], v[96:99], v[44:47], v[24:27]
    ds_read_b128 v[44:47], v9 offset:5120
    v_mul_f32_dpp v110, v166, v110 row_newbcast:5 row_mask:0xf bank_mask:0xf
    v_mul_f32_dpp v111, v167, v111 row_newbcast:5 row_mask:0xf bank_mask:0xf
    s_waitcnt lgkmcnt(4)
    v_mfma_f32_16x16x32_bf16 v[28:31], v[96:99], v[48:51], v[28:31]
    ds_read_b128 v[48:51], v9 offset:17408
    v_cvt_pk_bf16_f32 v104, v104, v105
    v_cvt_pk_bf16_f32 v105, v106, v107
    s_waitcnt lgkmcnt(4)
    v_mfma_f32_16x16x32_bf16 v[32:35], v[96:99], v[52:55], v[32:35]
    ds_read_b128 v[52:55], v9 offset:29696
    v_cvt_pk_bf16_f32 v106, v108, v109
    v_cvt_pk_bf16_f32 v107, v110, v111
    s_waitcnt lgkmcnt(4)
    v_mfma_f32_16x16x32_bf16 v[36:39], v[96:99], v[56:59], v[36:39]
    ds_read_b128 v[56:59], v9 offset:41984
    s_waitcnt lgkmcnt(4)
    v_mfma_f32_16x16x32_bf16 v[40:43], v[96:99], v[60:63], v[40:43]
    ds_read_b128 v[60:63], v10 offset:5120
    s_waitcnt lgkmcnt(4)
    v_mfma_f32_16x16x32_bf16 v[16:19], v[104:107], v[44:47], v[16:19]
    ds_read_b128 v[44:47], v10 offset:17408
    v_mul_f32_dpp v112, v160, v112 row_newbcast:6 row_mask:0xf bank_mask:0xf
    v_mul_f32_dpp v113, v161, v113 row_newbcast:6 row_mask:0xf bank_mask:0xf
    v_mul_f32_dpp v114, v162, v114 row_newbcast:6 row_mask:0xf bank_mask:0xf
    s_waitcnt lgkmcnt(4)
    v_mfma_f32_16x16x32_bf16 v[20:23], v[104:107], v[48:51], v[20:23]
    ds_read_b128 v[48:51], v10 offset:29696
    v_mul_f32_dpp v115, v163, v115 row_newbcast:6 row_mask:0xf bank_mask:0xf
    v_mul_f32_dpp v116, v164, v116 row_newbcast:6 row_mask:0xf bank_mask:0xf
    v_mul_f32_dpp v117, v165, v117 row_newbcast:6 row_mask:0xf bank_mask:0xf
    s_waitcnt lgkmcnt(4)
    v_mfma_f32_16x16x32_bf16 v[24:27], v[104:107], v[52:55], v[24:27]
    ds_read_b128 v[52:55], v9 offset:6144
    v_mul_f32_dpp v118, v166, v118 row_newbcast:6 row_mask:0xf bank_mask:0xf
    v_mul_f32_dpp v119, v167, v119 row_newbcast:6 row_mask:0xf bank_mask:0xf
    s_waitcnt lgkmcnt(4)
    v_mfma_f32_16x16x32_bf16 v[28:31], v[104:107], v[56:59], v[28:31]
    ds_read_b128 v[56:59], v9 offset:18432
    v_cvt_pk_bf16_f32 v112, v112, v113
    v_cvt_pk_bf16_f32 v113, v114, v115
    s_waitcnt lgkmcnt(4)
    v_mfma_f32_16x16x32_bf16 v[32:35], v[104:107], v[60:63], v[32:35]
    ds_read_b128 v[60:63], v9 offset:30720
    v_cvt_pk_bf16_f32 v114, v116, v117
    v_cvt_pk_bf16_f32 v115, v118, v119
    s_waitcnt lgkmcnt(4)
    v_mfma_f32_16x16x32_bf16 v[36:39], v[104:107], v[44:47], v[36:39]
    ds_read_b128 v[44:47], v9 offset:43008
    s_waitcnt lgkmcnt(4)
    v_mfma_f32_16x16x32_bf16 v[40:43], v[104:107], v[48:51], v[40:43]
    ds_read_b128 v[48:51], v10 offset:6144
    s_waitcnt lgkmcnt(4)
    v_mfma_f32_16x16x32_bf16 v[16:19], v[112:115], v[52:55], v[16:19]
    ds_read_b128 v[52:55], v10 offset:18432
    v_mul_f32_dpp v120, v160, v120 row_newbcast:7 row_mask:0xf bank_mask:0xf
    v_mul_f32_dpp v121, v161, v121 row_newbcast:7 row_mask:0xf bank_mask:0xf
    v_mul_f32_dpp v122, v162, v122 row_newbcast:7 row_mask:0xf bank_mask:0xf
    s_waitcnt lgkmcnt(4)
    v_mfma_f32_16x16x32_bf16 v[20:23], v[112:115], v[56:59], v[20:23]
    ds_read_b128 v[56:59], v10 offset:30720
    v_mul_f32_dpp v123, v163, v123 row_newbcast:7 row_mask:0xf bank_mask:0xf
    v_mul_f32_dpp v124, v164, v124 row_newbcast:7 row_mask:0xf bank_mask:0xf
    v_mul_f32_dpp v125, v165, v125 row_newbcast:7 row_mask:0xf bank_mask:0xf
    s_waitcnt lgkmcnt(4)
    v_mfma_f32_16x16x32_bf16 v[24:27], v[112:115], v[60:63], v[24:27]
    ds_read_b128 v[60:63], v9 offset:7168
    v_mul_f32_dpp v126, v166, v126 row_newbcast:7 row_mask:0xf bank_mask:0xf
    v_mul_f32_dpp v127, v167, v127 row_newbcast:7 row_mask:0xf bank_mask:0xf
    s_waitcnt lgkmcnt(4)
    v_mfma_f32_16x16x32_bf16 v[28:31], v[112:115], v[44:47], v[28:31]
    ds_read_b128 v[44:47], v9 offset:19456
    v_cvt_pk_bf16_f32 v120, v120, v121
    v_cvt_pk_bf16_f32 v121, v122, v123
    s_waitcnt lgkmcnt(4)
    v_mfma_f32_16x16x32_bf16 v[32:35], v[112:115], v[48:51], v[32:35]
    ds_read_b128 v[48:51], v9 offset:31744
    v_cvt_pk_bf16_f32 v122, v124, v125
    v_cvt_pk_bf16_f32 v123, v126, v127
    s_waitcnt lgkmcnt(4)
    v_mfma_f32_16x16x32_bf16 v[36:39], v[112:115], v[52:55], v[36:39]
    ds_read_b128 v[52:55], v9 offset:44032
    s_waitcnt lgkmcnt(4)
    v_mfma_f32_16x16x32_bf16 v[40:43], v[112:115], v[56:59], v[40:43]
    ds_read_b128 v[56:59], v10 offset:7168
    s_waitcnt lgkmcnt(4)
    v_mfma_f32_16x16x32_bf16 v[16:19], v[120:123], v[60:63], v[16:19]
    ds_read_b128 v[60:63], v10 offset:19456
    v_mul_f32_dpp v128, v160, v128 row_newbcast:8 row_mask:0xf bank_mask:0xf
    v_mul_f32_dpp v129, v161, v129 row_newbcast:8 row_mask:0xf bank_mask:0xf
    v_mul_f32_dpp v130, v162, v130 row_newbcast:8 row_mask:0xf bank_mask:0xf
    s_waitcnt lgkmcnt(4)
    v_mfma_f32_16x16x32_bf16 v[20:23], v[120:123], v[44:47], v[20:23]
    ds_read_b128 v[44:47], v10 offset:31744
    v_mul_f32_dpp v131, v163, v131 row_newbcast:8 row_mask:0xf bank_mask:0xf
    v_mul_f32_dpp v132, v164, v132 row_newbcast:8 row_mask:0xf bank_mask:0xf
    v_mul_f32_dpp v133, v165, v133 row_newbcast:8 row_mask:0xf bank_mask:0xf
    s_waitcnt lgkmcnt(4)
    v_mfma_f32_16x16x32_bf16 v[24:27], v[120:123], v[48:51], v[24:27]
    ds_read_b128 v[48:51], v9 offset:8192
    v_mul_f32_dpp v134, v166, v134 row_newbcast:8 row_mask:0xf bank_mask:0xf
    v_mul_f32_dpp v135, v167, v135 row_newbcast:8 row_mask:0xf bank_mask:0xf
    s_waitcnt lgkmcnt(4)
    v_mfma_f32_16x16x32_bf16 v[28:31], v[120:123], v[52:55], v[28:31]
    ds_read_b128 v[52:55], v9 offset:20480
    v_cvt_pk_bf16_f32 v128, v128, v129
    v_cvt_pk_bf16_f32 v129, v130, v131
    s_waitcnt lgkmcnt(4)
    v_mfma_f32_16x16x32_bf16 v[32:35], v[120:123], v[56:59], v[32:35]
    ds_read_b128 v[56:59], v9 offset:32768
    v_cvt_pk_bf16_f32 v130, v132, v133
    v_cvt_pk_bf16_f32 v131, v134, v135
    s_waitcnt lgkmcnt(4)
    v_mfma_f32_16x16x32_bf16 v[36:39], v[120:123], v[60:63], v[36:39]
    ds_read_b128 v[60:63], v9 offset:45056
    s_waitcnt lgkmcnt(4)
    v_mfma_f32_16x16x32_bf16 v[40:43], v[120:123], v[44:47], v[40:43]
    ds_read_b128 v[44:47], v10 offset:8192
    s_waitcnt lgkmcnt(4)
    v_mfma_f32_16x16x32_bf16 v[16:19], v[128:131], v[48:51], v[16:19]
    ds_read_b128 v[48:51], v10 offset:20480
    v_mul_f32_dpp v136, v160, v136 row_newbcast:9 row_mask:0xf bank_mask:0xf
    v_mul_f32_dpp v137, v161, v137 row_newbcast:9 row_mask:0xf bank_mask:0xf
    v_mul_f32_dpp v138, v162, v138 row_newbcast:9 row_mask:0xf bank_mask:0xf
    s_waitcnt lgkmcnt(4)
    v_mfma_f32_16x16x32_bf16 v[20:23], v[128:131], v[52:55], v[20:23]
    ds_read_b128 v[52:55], v10 offset:32768
    v_mul_f32_dpp v139, v163, v139 row_newbcast:9 row_mask:0xf bank_mask:0xf
    v_mul_f32_dpp v140, v164, v140 row_newbcast:9 row_mask:0xf bank_mask:0xf
    v_mul_f32_dpp v141, v165, v141 row_newbcast:9 row_mask:0xf bank_mask:0xf
    s_waitcnt lgkmcnt(4)
    v_mfma_f32_16x16x32_bf16 v[24:27], v[128:131], v[56:59], v[24:27]
    ds_read_b128 v[56:59], v9 offset:9216
    v_mul_f32_dpp v142, v166, v142 row_newbcast:9 row_mask:0xf bank_mask:0xf
    v_mul_f32_dpp v143, v167, v143 row_newbcast:9 row_mask:0xf bank_mask:0xf
    s_waitcnt lgkmcnt(4)
    v_mfma_f32_16x16x32_bf16 v[28:31], v[128:131], v[60:63], v[28:31]
    ds_read_b128 v[60:63], v9 offset:21504
    v_cvt_pk_bf16_f32 v136, v136, v137
    v_cvt_pk_bf16_f32 v137, v138, v139
    s_waitcnt lgkmcnt(4)
    v_mfma_f32_16x16x32_bf16 v[32:35], v[128:131], v[44:47], v[32:35]
    ds_read_b128 v[44:47], v9 offset:33792
    v_cvt_pk_bf16_f32 v138, v140, v141
    v_cvt_pk_bf16_f32 v139, v142, v143
    s_waitcnt lgkmcnt(4)
    v_mfma_f32_16x16x32_bf16 v[36:39], v[128:131], v[48:51], v[36:39]
    ds_read_b128 v[48:51], v9 offset:46080
    s_waitcnt lgkmcnt(4)
    v_mfma_f32_16x16x32_bf16 v[40:43], v[128:131], v[52:55], v[40:43]
    ds_read_b128 v[52:55], v10 offset:9216
    s_waitcnt lgkmcnt(4)
    v_mfma_f32_16x16x32_bf16 v[16:19], v[136:139], v[56:59], v[16:19]
    ds_read_b128 v[56:59], v10 offset:21504
    v_mul_f32_dpp v144, v160, v144 row_newbcast:10 row_mask:0xf bank_mask:0xf
    v_mul_f32_dpp v145, v161, v145 row_newbcast:10 row_mask:0xf bank_mask:0xf
    v_mul_f32_dpp v146, v162, v146 row_newbcast:10 row_mask:0xf bank_mask:0xf
    s_waitcnt lgkmcnt(4)
    v_mfma_f32_16x16x32_bf16 v[20:23], v[136:139], v[60:63], v[20:23]
    ds_read_b128 v[60:63], v10 offset:33792
    v_mul_f32_dpp v147, v163, v147 row_newbcast:10 row_mask:0xf bank_mask:0xf
    v_mul_f32_dpp v148, v164, v148 row_newbcast:10 row_mask:0xf bank_mask:0xf
    v_mul_f32_dpp v149, v165, v149 row_newbcast:10 row_mask:0xf bank_mask:0xf
    s_waitcnt lgkmcnt(4)
    v_mfma_f32_16x16x32_bf16 v[24:27], v[136:139], v[44:47], v[24:27]
    ds_read_b128 v[44:47], v9 offset:10240
    v_mul_f32_dpp v150, v166, v150 row_newbcast:10 row_mask:0xf bank_mask:0xf
    v_mul_f32_dpp v151, v167, v151 row_newbcast:10 row_mask:0xf bank_mask:0xf
    s_waitcnt lgkmcnt(4)
    v_mfma_f32_16x16x32_bf16 v[28:31], v[136:139], v[48:51], v[28:31]
    ds_read_b128 v[48:51], v9 offset:22528
    v_cvt_pk_bf16_f32 v144, v144, v145
    v_cvt_pk_bf16_f32 v145, v146, v147
    s_waitcnt lgkmcnt(4)
    v_mfma_f32_16x16x32_bf16 v[32:35], v[136:139], v[52:55], v[32:35]
    ds_read_b128 v[52:55], v9 offset:34816
    v_cvt_pk_bf16_f32 v146, v148, v149
    v_cvt_pk_bf16_f32 v147, v150, v151
    s_waitcnt lgkmcnt(4)
    v_mfma_f32_16x16x32_bf16 v[36:39], v[136:139], v[56:59], v[36:39]
    ds_read_b128 v[56:59], v9 offset:47104
    s_waitcnt lgkmcnt(4)
    v_mfma_f32_16x16x32_bf16 v[40:43], v[136:139], v[60:63], v[40:43]
    ds_read_b128 v[60:63], v10 offset:10240
    s_waitcnt lgkmcnt(4)
    v_mfma_f32_16x16x32_bf16 v[16:19], v[144:147], v[44:47], v[16:19]
    ds_read_b128 v[44:47], v10 offset:22528
    v_mul_f32_dpp v152, v160, v152 row_newbcast:11 row_mask:0xf bank_mask:0xf
    v_mul_f32_dpp v153, v161, v153 row_newbcast:11 row_mask:0xf bank_mask:0xf
    v_mul_f32_dpp v154, v162, v154 row_newbcast:11 row_mask:0xf bank_mask:0xf
    s_waitcnt lgkmcnt(4)
    v_mfma_f32_16x16x32_bf16 v[20:23], v[144:147], v[48:51], v[20:23]
    ds_read_b128 v[48:51], v10 offset:34816
    v_mul_f32_dpp v155, v163, v155 row_newbcast:11 row_mask:0xf bank_mask:0xf
    v_mul_f32_dpp v156, v164, v156 row_newbcast:11 row_mask:0xf bank_mask:0xf
    v_mul_f32_dpp v157, v165, v157 row_newbcast:11 row_mask:0xf bank_mask:0xf
    s_waitcnt lgkmcnt(4)
    v_mfma_f32_16x16x32_bf16 v[24:27], v[144:147], v[52:55], v[24:27]
    ds_read_b128 v[52:55], v9 offset:11264
    v_mul_f32_dpp v158, v166, v158 row_newbcast:11 row_mask:0xf bank_mask:0xf
    v_mul_f32_dpp v159, v167, v159 row_newbcast:11 row_mask:0xf bank_mask:0xf
    s_waitcnt lgkmcnt(4)
    v_mfma_f32_16x16x32_bf16 v[28:31], v[144:147], v[56:59], v[28:31]
    ds_read_b128 v[56:59], v9 offset:23552
    v_cvt_pk_bf16_f32 v152, v152, v153
    v_cvt_pk_bf16_f32 v153, v154, v155
    s_waitcnt lgkmcnt(4)
    v_mfma_f32_16x16x32_bf16 v[32:35], v[144:147], v[60:63], v[32:35]
    ds_read_b128 v[60:63], v9 offset:35840
    v_cvt_pk_bf16_f32 v154, v156, v157
    v_cvt_pk_bf16_f32 v155, v158, v159
    s_waitcnt lgkmcnt(4)
    v_mfma_f32_16x16x32_bf16 v[36:39], v[144:147], v[44:47], v[36:39]
    ds_read_b128 v[44:47], v9 offset:48128
    s_waitcnt lgkmcnt(4)
    v_mfma_f32_16x16x32_bf16 v[40:43], v[144:147], v[48:51], v[40:43]
    ds_read_b128 v[48:51], v10 offset:11264
    s_waitcnt lgkmcnt(4)
    v_mfma_f32_16x16x32_bf16 v[16:19], v[152:155], v[52:55], v[16:19]
    ds_read_b128 v[52:55], v10 offset:23552
    s_waitcnt lgkmcnt(4)
    v_mfma_f32_16x16x32_bf16 v[20:23], v[152:155], v[56:59], v[20:23]
    ds_read_b128 v[56:59], v10 offset:35840
    s_waitcnt lgkmcnt(4)
    v_mfma_f32_16x16x32_bf16 v[24:27], v[152:155], v[60:63], v[24:27]
    s_waitcnt lgkmcnt(3)
    v_mfma_f32_16x16x32_bf16 v[28:31], v[152:155], v[44:47], v[28:31]
    s_waitcnt lgkmcnt(2)
    v_mfma_f32_16x16x32_bf16 v[32:35], v[152:155], v[48:51], v[32:35]
    s_waitcnt lgkmcnt(1)
    v_mfma_f32_16x16x32_bf16 v[36:39], v[152:155], v[52:55], v[36:39]
    s_waitcnt lgkmcnt(0)
    v_mfma_f32_16x16x32_bf16 v[40:43], v[152:155], v[56:59], v[40:43]
    s_nop 7
    v_cvt_pk_bf16_f32 v44, v16, v17
    v_cvt_pk_bf16_f32 v45, v18, v19
    buffer_store_dwordx2 v[44:45], v2, s[28:31], 0 offen
    v_cvt_pk_bf16_f32 v46, v20, v21
    v_cvt_pk_bf16_f32 v47, v22, v23
    buffer_store_dwordx2 v[46:47], v3, s[28:31], 0 offen
    v_cvt_pk_bf16_f32 v48, v24, v25
    v_cvt_pk_bf16_f32 v49, v26, v27
    buffer_store_dwordx2 v[48:49], v4, s[28:31], 0 offen
    v_cvt_pk_bf16_f32 v50, v28, v29
    v_cvt_pk_bf16_f32 v51, v30, v31
    buffer_store_dwordx2 v[50:51], v5, s[28:31], 0 offen
    v_cvt_pk_bf16_f32 v52, v32, v33
    v_cvt_pk_bf16_f32 v53, v34, v35
    buffer_store_dwordx2 v[52:53], v6, s[28:31], 0 offen
    v_cvt_pk_bf16_f32 v54, v36, v37
    v_cvt_pk_bf16_f32 v55, v38, v39
    buffer_store_dwordx2 v[54:55], v7, s[28:31], 0 offen
    v_cvt_pk_bf16_f32 v56, v40, v41
    v_cvt_pk_bf16_f32 v57, v42, v43
    buffer_store_dwordx2 v[56:57], v8, s[28:31], 0 offen
    s_branch L_fin
L_g2b:
    ds_read_b128 v[160:163], v12
    ds_read_b128 v[164:167], v12 offset:64
    ds_read_b128 v[44:47], v9 offset:0
    ds_read_b128 v[48:51], v9 offset:12288
    ds_read_b128 v[52:55], v9 offset:24576
    ds_read_b128 v[56:59], v9 offset:36864
    ds_read_b128 v[60:63], v10 offset:0
    s_waitcnt lgkmcnt(5)
    v_mul_f32_dpp v64, v160, v64 row_newbcast:0 row_mask:0xf bank_mask:0xf
    v_mul_f32_dpp v65, v161, v65 row_newbcast:0 row_mask:0xf bank_mask:0xf
    v_mul_f32_dpp v66, v162, v66 row_newbcast:0 row_mask:0xf bank_mask:0xf
    v_mul_f32_dpp v67, v163, v67 row_newbcast:0 row_mask:0xf bank_mask:0xf
    v_mul_f32_dpp v68, v164, v68 row_newbcast:0 row_mask:0xf bank_mask:0xf
    v_mul_f32_dpp v69, v165, v69 row_newbcast:0 row_mask:0xf bank_mask:0xf
    v_mul_f32_dpp v70, v166, v70 row_newbcast:0 row_mask:0xf bank_mask:0xf
    v_mul_f32_dpp v71, v167, v71 row_newbcast:0 row_mask:0xf bank_mask:0xf
    v_cvt_pk_bf16_f32 v64, v64, v65
    v_cvt_pk_bf16_f32 v65, v66, v67
    v_cvt_pk_bf16_f32 v66, v68, v69
    v_cvt_pk_bf16_f32 v67, v70, v71
    s_nop 1
    s_waitcnt lgkmcnt(4)
    v_mfma_f32_16x16x32_bf16 v[16:19], v[64:67], v[44:47], v[16:19]
    ds_read_b128 v[44:47], v11 offset:0
    v_mul_f32_dpp v72, v160, v72 row_newbcast:1 row_mask:0xf bank_mask:0xf
    v_mul_f32_dpp v73, v161, v73 row_newbcast:1 row_mask:0xf bank_mask:0xf
    v_mul_f32_dpp v74, v162, v74 row_newbcast:1 row_mask:0xf bank_mask:0xf
    s_waitcnt lgkmcnt(4)
    v_mfma_f32_16x16x32_bf16 v[20:23], v[64:67], v[48:51], v[20:23]
    ds_read_b128 v[48:51], v9 offset:1024
    v_mul_f32_dpp v75, v163, v75 row_newbcast:1 row_mask:0xf bank_mask:0xf
    v_mul_f32_dpp v76, v164, v76 row_newbcast:1 row_mask:0xf bank_mask:0xf
    v_mul_f32_dpp v77, v165, v77 row_newbcast:1 row_mask:0xf bank_mask:0xf
    s_waitcnt lgkmcnt(4)
    v_mfma_f32_16x16x32_bf16 v[24:27], v[64:67], v[52:55], v[24:27]
    ds_read_b128 v[52:55], v9 offset:13312
    v_mul_f32_dpp v78, v166, v78 row_newbcast:1 row_mask:0xf bank_mask:0xf
    v_mul_f32_dpp v79, v167, v79 row_newbcast:1 row_mask:0xf bank_mask:0xf
    s_waitcnt lgkmcnt(4)
    v_mfma_f32_16x16x32_bf16 v[28:31], v[64:67], v[56:59], v[28:31]
    ds_read_b128 v[56:59], v9 offset:25600
    v_cvt_pk_bf16_f32 v72, v72, v73
    v_cvt_pk_bf16_f32 v73, v74, v75
    s_waitcnt lgkmcnt(4)
    v_mfma_f32_16x16x32_bf16 v[32:35], v[64:67], v[60:63], v[32:35]
    ds_read_b128 v[60:63], v9 offset:37888
    v_cvt_pk_bf16_f32 v74, v76, v77
    v_cvt_pk_bf16_f32 v75, v78, v79
    s_waitcnt lgkmcnt(4)
    v_mfma_f32_16x16x32_bf16 v[36:39], v[64:67], v[44:47], v[36:39]
    ds_read_b128 v[44:47], v10 offset:1024
    s_waitcnt lgkmcnt(4)
    v_mfma_f32_16x16x32_bf16 v[16:19], v[72:75], v[48:51], v[16:19]
    ds_read_b128 v[48:51], v11 offset:256
    v_mul_f32_dpp v80, v160, v80 row_newbcast:2 row_mask:0xf bank_mask:0xf
    v_mul_f32_dpp v81, v161, v81 row_newbcast:2 row_mask:0xf bank_mask:0xf
    v_mul_f32_dpp v82, v162, v82 row_newbcast:2 row_mask:0xf bank_mask:0xf
    s_waitcnt lgkmcnt(4)
    v_mfma_f32_16x16x32_bf16 v[20:23], v[72:75], v[52:55], v[20:23]
    ds_read_b128 v[52:55], v9 offset:2048
    v_mul_f32_dpp v83, v163, v83 row_newbcast:2 row_mask:0xf bank_mask:0xf
    v_mul_f32_dpp v84, v164, v84 row_newbcast:2 row_mask:0xf bank_mask:0xf
    v_mul_f32_dpp v85, v165, v85 row_newbcast:2 row_mask:0xf bank_mask:0xf
    s_waitcnt lgkmcnt(4)
    v_mfma_f32_16x16x32_bf16 v[24:27], v[72:75], v[56:59], v[24:27]
    ds_read_b128 v[56:59], v9 offset:14336
    v_mul_f32_dpp v86, v166, v86 row_newbcast:2 row_mask:0xf bank_mask:0xf
    v_mul_f32_dpp v87, v167, v87 row_newbcast:2 row_mask:0xf bank_mask:0xf
    s_waitcnt lgkmcnt(4)
    v_mfma_f32_16x16x32_bf16 v[28:31], v[72:75], v[60:63], v[28:31]
    ds_read_b128 v[60:63], v9 offset:26624
    v_cvt_pk_bf16_f32 v80, v80, v81
    v_cvt_pk_bf16_f32 v81, v82, v83
    s_waitcnt lgkmcnt(4)
    v_mfma_f32_16x16x32_bf16 v[32:35], v[72:75], v[44:47], v[32:35]
    ds_read_b128 v[44:47], v9 offset:38912
    v_cvt_pk_bf16_f32 v82, v84, v85
    v_cvt_pk_bf16_f32 v83, v86, v87
    s_waitcnt lgkmcnt(4)
    v_mfma_f32_16x16x32_bf16 v[36:39], v[72:75], v[48:51], v[36:39]
    ds_read_b128 v[48:51], v10 offset:2048
    s_waitcnt lgkmcnt(4)
    v_mfma_f32_16x16x32_bf16 v[16:19], v[80:83], v[52:55], v[16:19]
    ds_read_b128 v[52:55], v11 offset:512
    v_mul_f32_dpp v88, v160, v88 row_newbcast:3 row_mask:0xf bank_mask:0xf
    v_mul_f32_dpp v89, v161, v89 row_newbcast:3 row_mask:0xf bank_mask:0xf
    v_mul_f32_dpp v90, v162, v90 row_newbcast:3 row_mask:0xf bank_mask:0xf
    s_waitcnt lgkmcnt(4)
    v_mfma_f32_16x16x32_bf16 v[20:23], v[80:83], v[56:59], v[20:23]
    ds_read_b128 v[56:59], v9 offset:3072
    v_mul_f32_dpp v91, v163, v91 row_newbcast:3 row_mask:0xf bank_mask:0xf
    v_mul_f32_dpp v92, v164, v92 row_newbcast:3 row_mask:0xf bank_mask:0xf
    v_mul_f32_dpp v93, v165, v93 row_newbcast:3 row_mask:0xf bank_mask:0xf
    s_waitcnt lgkmcnt(4)
    v_mfma_f32_16x16x32_bf16 v[24:27], v[80:83], v[60:63], v[24:27]
    ds_read_b128 v[60:63], v9 offset:15360
    v_mul_f32_dpp v94, v166, v94 row_newbcast:3 row_mask:0xf bank_mask:0xf
    v_mul_f32_dpp v95, v167, v95 row_newbcast:3 row_mask:0xf bank_mask:0xf
    s_waitcnt lgkmcnt(4)
    v_mfma_f32_16x16x32_bf16 v[28:31], v[80:83], v[44:47], v[28:31]
    ds_read_b128 v[44:47], v9 offset:27648
    v_cvt_pk_bf16_f32 v88, v88, v89
    v_cvt_pk_bf16_f32 v89, v90, v91
    s_waitcnt lgkmcnt(4)
    v_mfma_f32_16x16x32_bf16 v[32:35], v[80:83], v[48:51], v[32:35]
    ds_read_b128 v[48:51], v9 offset:39936
    v_cvt_pk_bf16_f32 v90, v92, v93
    v_cvt_pk_bf16_f32 v91, v94, v95
    s_waitcnt lgkmcnt(4)
    v_mfma_f32_16x16x32_bf16 v[36:39], v[80:83], v[52:55], v[36:39]
    ds_read_b128 v[52:55], v10 offset:3072
    s_waitcnt lgkmcnt(4)
    v_mfma_f32_16x16x32_bf16 v[16:19], v[88:91], v[56:59], v[16:19]
    ds_read_b128 v[56:59], v11 offset:768
    v_mul_f32_dpp v96, v160, v96 row_newbcast:4 row_mask:0xf bank_mask:0xf
    v_mul_f32_dpp v97, v161, v97 row_newbcast:4 row_mask:0xf bank_mask:0xf
    v_mul_f32_dpp v98, v162, v98 row_newbcast:4 row_mask:0xf bank_mask:0xf
    s_waitcnt lgkmcnt(4)
    v_mfma_f32_16x16x32_bf16 v[20:23], v[88:91], v[60:63], v[20:23]
    ds_read_b128 v[60:63], v9 offset:4096
    v_mul_f32_dpp v99, v163, v99 row_newbcast:4 row_mask:0xf bank_mask:0xf
    v_mul_f32_dpp v100, v164, v100 row_newbcast:4 row_mask:0xf bank_mask:0xf
    v_mul_f32_dpp v101, v165, v101 row_newbcast:4 row_mask:0xf bank_mask:0xf
    s_waitcnt lgkmcnt(4)
    v_mfma_f32_16x16x32_bf16 v[24:27], v[88:91], v[44:47], v[24:27]
    ds_read_b128 v[44:47], v9 offset:16384
    v_mul_f32_dpp v102, v166, v102 row_newbcast:4 row_mask:0xf bank_mask:0xf
    v_mul_f32_dpp v103, v167, v103 row_newbcast:4 row_mask:0xf bank_mask:0xf
    s_waitcnt lgkmcnt(4)
    v_mfma_f32_16x16x32_bf16 v[28:31], v[88:91], v[48:51], v[28:31]
    ds_read_b128 v[48:51], v9 offset:28672
    v_cvt_pk_bf16_f32 v96, v96, v97
    v_cvt_pk_bf16_f32 v97, v98, v99
    s_waitcnt lgkmcnt(4)
    v_mfma_f32_16x16x32_bf16 v[32:35], v[88:91], v[52:55], v[32:35]
    ds_read_b128 v[52:55], v9 offset:40960
    v_cvt_pk_bf16_f32 v98, v100, v101
    v_cvt_pk_bf16_f32 v99, v102, v103
    s_waitcnt lgkmcnt(4)
    v_mfma_f32_16x16x32_bf16 v[36:39], v[88:91], v[56:59], v[36:39]
    ds_read_b128 v[56:59], v10 offset:4096
    s_waitcnt lgkmcnt(4)
    v_mfma_f32_16x16x32_bf16 v[16:19], v[96:99], v[60:63], v[16:19]
    ds_read_b128 v[60:63], v11 offset:1024
    v_mul_f32_dpp v104, v160, v104 row_newbcast:5 row_mask:0xf bank_mask:0xf
    v_mul_f32_dpp v105, v161, v105 row_newbcast:5 row_mask:0xf bank_mask:0xf
    v_mul_f32_dpp v106, v162, v106 row_newbcast:5 row_mask:0xf bank_mask:0xf
    s_waitcnt lgkmcnt(4)
    v_mfma_f32_16x16x32_bf16 v[20:23], v[96:99], v[44:47], v[20:23]
    ds_read_b128 v[44:47], v9 offset:5120
    v_mul_f32_dpp v107, v163, v107 row_newbcast:5 row_mask:0xf bank_mask:0xf
    v_mul_f32_dpp v108, v164, v108 row_newbcast:5 row_mask:0xf bank_mask:0xf
    v_mul_f32_dpp v109, v165, v109 row_newbcast:5 row_mask:0xf bank_mask:0xf
    s_waitcnt lgkmcnt(4)
    v_mfma_f32_16x16x32_bf16 v[24:27], v[96:99], v[48:51], v[24:27]
    ds_read_b128 v[48:51], v9 offset:17408
    v_mul_f32_dpp v110, v166, v110 row_newbcast:5 row_mask:0xf bank_mask:0xf
    v_mul_f32_dpp v111, v167, v111 row_newbcast:5 row_mask:0xf bank_mask:0xf
    s_waitcnt lgkmcnt(4)
    v_mfma_f32_16x16x32_bf16 v[28:31], v[96:99], v[52:55], v[28:31]
    ds_read_b128 v[52:55], v9 offset:29696
    v_cvt_pk_bf16_f32 v104, v104, v105
    v_cvt_pk_bf16_f32 v105, v106, v107
    s_waitcnt lgkmcnt(4)
    v_mfma_f32_16x16x32_bf16 v[32:35], v[96:99], v[56:59], v[32:35]
    ds_read_b128 v[56:59], v9 offset:41984
    v_cvt_pk_bf16_f32 v106, v108, v109
    v_cvt_pk_bf16_f32 v107, v110, v111
    s_waitcnt lgkmcnt(4)
    v_mfma_f32_16x16x32_bf16 v[36:39], v[96:99], v[60:63], v[36:39]
    ds_read_b128 v[60:63], v10 offset:5120
    s_waitcnt lgkmcnt(4)
    v_mfma_f32_16x16x32_bf16 v[16:19], v[104:107], v[44:47], v[16:19]
    ds_read_b128 v[44:47], v11 offset:1280
    v_mul_f32_dpp v112, v160, v112 row_newbcast:6 row_mask:0xf bank_mask:0xf
    v_mul_f32_dpp v113, v161, v113 row_newbcast:6 row_mask:0xf bank_mask:0xf
    v_mul_f32_dpp v114, v162, v114 row_newbcast:6 row_mask:0xf bank_mask:0xf
    s_waitcnt lgkmcnt(4)
    v_mfma_f32_16x16x32_bf16 v[20:23], v[104:107], v[48:51], v[20:23]
    ds_read_b128 v[48:51], v9 offset:6144
    v_mul_f32_dpp v115, v163, v115 row_newbcast:6 row_mask:0xf bank_mask:0xf
    v_mul_f32_dpp v116, v164, v116 row_newbcast:6 row_mask:0xf bank_mask:0xf
    v_mul_f32_dpp v117, v165, v117 row_newbcast:6 row_mask:0xf bank_mask:0xf
    s_waitcnt lgkmcnt(4)
    v_mfma_f32_16x16x32_bf16 v[24:27], v[104:107], v[52:55], v[24:27]
    ds_read_b128 v[52:55], v9 offset:18432
    v_mul_f32_dpp v118, v166, v118 row_newbcast:6 row_mask:0xf bank_mask:0xf
    v_mul_f32_dpp v119, v167, v119 row_newbcast:6 row_mask:0xf bank_mask:0xf
    s_waitcnt lgkmcnt(4)
    v_mfma_f32_16x16x32_bf16 v[28:31], v[104:107], v[56:59], v[28:31]
    ds_read_b128 v[56:59], v9 offset:30720
    v_cvt_pk_bf16_f32 v112, v112, v113
    v_cvt_pk_bf16_f32 v113, v114, v115
    s_waitcnt lgkmcnt(4)
    v_mfma_f32_16x16x32_bf16 v[32:35], v[104:107], v[60:63], v[32:35]
    ds_read_b128 v[60:63], v9 offset:43008
    v_cvt_pk_bf16_f32 v114, v116, v117
    v_cvt_pk_bf16_f32 v115, v118, v119
    s_waitcnt lgkmcnt(4)
    v_mfma_f32_16x16x32_bf16 v[36:39], v[104:107], v[44:47], v[36:39]
    ds_read_b128 v[44:47], v10 offset:6144
    s_waitcnt lgkmcnt(4)
    v_mfma_f32_16x16x32_bf16 v[16:19], v[112:115], v[48:51], v[16:19]
    ds_read_b128 v[48:51], v11 offset:1536
    v_mul_f32_dpp v120, v160, v120 row_newbcast:7 row_mask:0xf bank_mask:0xf
    v_mul_f32_dpp v121, v161, v121 row_newbcast:7 row_mask:0xf bank_mask:0xf
    v_mul_f32_dpp v122, v162, v122 row_newbcast:7 row_mask:0xf bank_mask:0xf
    s_waitcnt lgkmcnt(4)
    v_mfma_f32_16x16x32_bf16 v[20:23], v[112:115], v[52:55], v[20:23]
    ds_read_b128 v[52:55], v9 offset:7168
    v_mul_f32_dpp v123, v163, v123 row_newbcast:7 row_mask:0xf bank_mask:0xf
    v_mul_f32_dpp v124, v164, v124 row_newbcast:7 row_mask:0xf bank_mask:0xf
    v_mul_f32_dpp v125, v165, v125 row_newbcast:7 row_mask:0xf bank_mask:0xf
    s_waitcnt lgkmcnt(4)
    v_mfma_f32_16x16x32_bf16 v[24:27], v[112:115], v[56:59], v[24:27]
    ds_read_b128 v[56:59], v9 offset:19456
    v_mul_f32_dpp v126, v166, v126 row_newbcast:7 row_mask:0xf bank_mask:0xf
    v_mul_f32_dpp v127, v167, v127 row_newbcast:7 row_mask:0xf bank_mask:0xf
    s_waitcnt lgkmcnt(4)
    v_mfma_f32_16x16x32_bf16 v[28:31], v[112:115], v[60:63], v[28:31]
    ds_read_b128 v[60:63], v9 offset:31744
    v_cvt_pk_bf16_f32 v120, v120, v121
    v_cvt_pk_bf16_f32 v121, v122, v123
    s_waitcnt lgkmcnt(4)
    v_mfma_f32_16x16x32_bf16 v[32:35], v[112:115], v[44:47], v[32:35]
    ds_read_b128 v[44:47], v9 offset:44032
    v_cvt_pk_bf16_f32 v122, v124, v125
    v_cvt_pk_bf16_f32 v123, v126, v127
    s_waitcnt lgkmcnt(4)
    v_mfma_f32_16x16x32_bf16 v[36:39], v[112:115], v[48:51], v[36:39]
    ds_read_b128 v[48:51], v10 offset:7168
    s_waitcnt lgkmcnt(4)
    v_mfma_f32_16x16x32_bf16 v[16:19], v[120:123], v[52:55], v[16:19]
    ds_read_b128 v[52:55], v11 offset:1792
    v_mul_f32_dpp v128, v160, v128 row_newbcast:8 row_mask:0xf bank_mask:0xf
    v_mul_f32_dpp v129, v161, v129 row_newbcast:8 row_mask:0xf bank_mask:0xf
    v_mul_f32_dpp v130, v162, v130 row_newbcast:8 row_mask:0xf bank_mask:0xf
    s_waitcnt lgkmcnt(4)
    v_mfma_f32_16x16x32_bf16 v[20:23], v[120:123], v[56:59], v[20:23]
    ds_read_b128 v[56:59], v9 offset:8192
    v_mul_f32_dpp v131, v163, v131 row_newbcast:8 row_mask:0xf bank_mask:0xf
    v_mul_f32_dpp v132, v164, v132 row_newbcast:8 row_mask:0xf bank_mask:0xf
    v_mul_f32_dpp v133, v165, v133 row_newbcast:8 row_mask:0xf bank_mask:0xf
    s_waitcnt lgkmcnt(4)
    v_mfma_f32_16x16x32_bf16 v[24:27], v[120:123], v[60:63], v[24:27]
    ds_read_b128 v[60:63], v9 offset:20480
    v_mul_f32_dpp v134, v166, v134 row_newbcast:8 row_mask:0xf bank_mask:0xf
    v_mul_f32_dpp v135, v167, v135 row_newbcast:8 row_mask:0xf bank_mask:0xf
    s_waitcnt lgkmcnt(4)
    v_mfma_f32_16x16x32_bf16 v[28:31], v[120:123], v[44:47], v[28:31]
    ds_read_b128 v[44:47], v9 offset:32768
    v_cvt_pk_bf16_f32 v128, v128, v129
    v_cvt_pk_bf16_f32 v129, v130, v131
    s_waitcnt lgkmcnt(4)
    v_mfma_f32_16x16x32_bf16 v[32:35], v[120:123], v[48:51], v[32:35]
    ds_read_b128 v[48:51], v9 offset:45056
    v_cvt_pk_bf16_f32 v130, v132, v133
    v_cvt_pk_bf16_f32 v131, v134, v135
    s_waitcnt lgkmcnt(4)
    v_mfma_f32_16x16x32_bf16 v[36:39], v[120:123], v[52:55], v[36:39]
    ds_read_b128 v[52:55], v10 offset:8192
    s_waitcnt lgkmcnt(4)
    v_mfma_f32_16x16x32_bf16 v[16:19], v[128:131], v[56:59], v[16:19]
    ds_read_b128 v[56:59], v11 offset:2048
    v_mul_f32_dpp v136, v160, v136 row_newbcast:9 row_mask:0xf bank_mask:0xf
    v_mul_f32_dpp v137, v161, v137 row_newbcast:9 row_mask:0xf bank_mask:0xf
    v_mul_f32_dpp v138, v162, v138 row_newbcast:9 row_mask:0xf bank_mask:0xf
    s_waitcnt lgkmcnt(4)
    v_mfma_f32_16x16x32_bf16 v[20:23], v[128:131], v[60:63], v[20:23]
    ds_read_b128 v[60:63], v9 offset:9216
    v_mul_f32_dpp v139, v163, v139 row_newbcast:9 row_mask:0xf bank_mask:0xf
    v_mul_f32_dpp v140, v164, v140 row_newbcast:9 row_mask:0xf bank_mask:0xf
    v_mul_f32_dpp v141, v165, v141 row_newbcast:9 row_mask:0xf bank_mask:0xf
    s_waitcnt lgkmcnt(4)
    v_mfma_f32_16x16x32_bf16 v[24:27], v[128:131], v[44:47], v[24:27]
    ds_read_b128 v[44:47], v9 offset:21504
    v_mul_f32_dpp v142, v166, v142 row_newbcast:9 row_mask:0xf bank_mask:0xf
    v_mul_f32_dpp v143, v167, v143 row_newbcast:9 row_mask:0xf bank_mask:0xf
    s_waitcnt lgkmcnt(4)
    v_mfma_f32_16x16x32_bf16 v[28:31], v[128:131], v[48:51], v[28:31]
    ds_read_b128 v[48:51], v9 offset:33792
    v_cvt_pk_bf16_f32 v136, v136, v137
    v_cvt_pk_bf16_f32 v137, v138, v139
    s_waitcnt lgkmcnt(4)
    v_mfma_f32_16x16x32_bf16 v[32:35], v[128:131], v[52:55], v[32:35]
    ds_read_b128 v[52:55], v9 offset:46080
    v_cvt_pk_bf16_f32 v138, v140, v141
    v_cvt_pk_bf16_f32 v139, v142, v143
    s_waitcnt lgkmcnt(4)
    v_mfma_f32_16x16x32_bf16 v[36:39], v[128:131], v[56:59], v[36:39]
    ds_read_b128 v[56:59], v10 offset:9216
    s_waitcnt lgkmcnt(4)
    v_mfma_f32_16x16x32_bf16 v[16:19], v[136:139], v[60:63], v[16:19]
    ds_read_b128 v[60:63], v11 offset:2304
    v_mul_f32_dpp v144, v160, v144 row_newbcast:10 row_mask:0xf bank_mask:0xf
    v_mul_f32_dpp v145, v161, v145 row_newbcast:10 row_mask:0xf bank_mask:0xf
    v_mul_f32_dpp v146, v162, v146 row_newbcast:10 row_mask:0xf bank_mask:0xf
    s_waitcnt lgkmcnt(4)
    v_mfma_f32_16x16x32_bf16 v[20:23], v[136:139], v[44:47], v[20:23]
    ds_read_b128 v[44:47], v9 offset:10240
    v_mul_f32_dpp v147, v163, v147 row_newbcast:10 row_mask:0xf bank_mask:0xf
    v_mul_f32_dpp v148, v164, v148 row_newbcast:10 row_mask:0xf bank_mask:0xf
    v_mul_f32_dpp v149, v165, v149 row_newbcast:10 row_mask:0xf bank_mask:0xf
    s_waitcnt lgkmcnt(4)
    v_mfma_f32_16x16x32_bf16 v[24:27], v[136:139], v[48:51], v[24:27]
    ds_read_b128 v[48:51], v9 offset:22528
    v_mul_f32_dpp v150, v166, v150 row_newbcast:10 row_mask:0xf bank_mask:0xf
    v_mul_f32_dpp v151, v167, v151 row_newbcast:10 row_mask:0xf bank_mask:0xf
    s_waitcnt lgkmcnt(4)
    v_mfma_f32_16x16x32_bf16 v[28:31], v[136:139], v[52:55], v[28:31]
    ds_read_b128 v[52:55], v9 offset:34816
    v_cvt_pk_bf16_f32 v144, v144, v145
    v_cvt_pk_bf16_f32 v145, v146, v147
    s_waitcnt lgkmcnt(4)
    v_mfma_f32_16x16x32_bf16 v[32:35], v[136:139], v[56:59], v[32:35]
    ds_read_b128 v[56:59], v9 offset:47104
    v_cvt_pk_bf16_f32 v146, v148, v149
    v_cvt_pk_bf16_f32 v147, v150, v151
    s_waitcnt lgkmcnt(4)
    v_mfma_f32_16x16x32_bf16 v[36:39], v[136:139], v[60:63], v[36:39]
    ds_read_b128 v[60:63], v10 offset:10240
    s_waitcnt lgkmcnt(4)
    v_mfma_f32_16x16x32_bf16 v[16:19], v[144:147], v[44:47], v[16:19]
    ds_read_b128 v[44:47], v11 offset:2560
    v_mul_f32_dpp v152, v160, v152 row_newbcast:11 row_mask:0xf bank_mask:0xf
    v_mul_f32_dpp v153, v161, v153 row_newbcast:11 row_mask:0xf bank_mask:0xf
    v_mul_f32_dpp v154, v162, v154 row_newbcast:11 row_mask:0xf bank_mask:0xf
    s_waitcnt lgkmcnt(4)
    v_mfma_f32_16x16x32_bf16 v[20:23], v[144:147], v[48:51], v[20:23]
    ds_read_b128 v[48:51], v9 offset:11264
    v_mul_f32_dpp v155, v163, v155 row_newbcast:11 row_mask:0xf bank_mask:0xf
    v_mul_f32_dpp v156, v164, v156 row_newbcast:11 row_mask:0xf bank_mask:0xf
    v_mul_f32_dpp v157, v165, v157 row_newbcast:11 row_mask:0xf bank_mask:0xf
    s_waitcnt lgkmcnt(4)
    v_mfma_f32_16x16x32_bf16 v[24:27], v[144:147], v[52:55], v[24:27]
    ds_read_b128 v[52:55], v9 offset:23552
    v_mul_f32_dpp v158, v166, v158 row_newbcast:11 row_mask:0xf bank_mask:0xf
    v_mul_f32_dpp v159, v167, v159 row_newbcast:11 row_mask:0xf bank_mask:0xf
    s_waitcnt lgkmcnt(4)
    v_mfma_f32_16x16x32_bf16 v[28:31], v[144:147], v[56:59], v[28:31]
    ds_read_b128 v[56:59], v9 offset:35840
    v_cvt_pk_bf16_f32 v152, v152, v153
    v_cvt_pk_bf16_f32 v153, v154, v155
    s_waitcnt lgkmcnt(4)
    v_mfma_f32_16x16x32_bf16 v[32:35], v[144:147], v[60:63], v[32:35]
    ds_read_b128 v[60:63], v9 offset:48128
    v_cvt_pk_bf16_f32 v154, v156, v157
    v_cvt_pk_bf16_f32 v155, v158, v159
    s_waitcnt lgkmcnt(4)
    v_mfma_f32_16x16x32_bf16 v[36:39], v[144:147], v[44:47], v[36:39]
    ds_read_b128 v[44:47], v10 offset:11264
    s_waitcnt lgkmcnt(4)
    v_mfma_f32_16x16x32_bf16 v[16:19], v[152:155], v[48:51], v[16:19]
    ds_read_b128 v[48:51], v11 offset:2816
    s_waitcnt lgkmcnt(4)
    v_mfma_f32_16x16x32_bf16 v[20:23], v[152:155], v[52:55], v[20:23]
    s_waitcnt lgkmcnt(3)
    v_mfma_f32_16x16x32_bf16 v[24:27], v[152:155], v[56:59], v[24:27]
    s_waitcnt lgkmcnt(2)
    v_mfma_f32_16x16x32_bf16 v[28:31], v[152:155], v[60:63], v[28:31]
    s_waitcnt lgkmcnt(1)
    v_mfma_f32_16x16x32_bf16 v[32:35], v[152:155], v[44:47], v[32:35]
    s_waitcnt lgkmcnt(0)
    v_mfma_f32_16x16x32_bf16 v[36:39], v[152:155], v[48:51], v[36:39]
    s_nop 7
    v_cvt_pk_bf16_f32 v44, v16, v17
    v_cvt_pk_bf16_f32 v45, v18, v19
    buffer_store_dwordx2 v[44:45], v2, s[28:31], 0 offen
    v_cvt_pk_bf16_f32 v46, v20, v21
    v_cvt_pk_bf16_f32 v47, v22, v23
    buffer_store_dwordx2 v[46:47], v3, s[28:31], 0 offen
    v_cvt_pk_bf16_f32 v48, v24, v25
    v_cvt_pk_bf16_f32 v49, v26, v27
    buffer_store_dwordx2 v[48:49], v4, s[28:31], 0 offen
    v_cvt_pk_bf16_f32 v50, v28, v29
    v_cvt_pk_bf16_f32 v51, v30, v31
    buffer_store_dwordx2 v[50:51], v5, s[28:31], 0 offen
    v_cvt_pk_bf16_f32 v52, v32, v33
    v_cvt_pk_bf16_f32 v53, v34, v35
    buffer_store_dwordx2 v[52:53], v6, s[28:31], 0 offen
    v_cvt_pk_bf16_f32 v54, v36, v37
    v_cvt_pk_bf16_f32 v55, v38, v39
    buffer_store_dwordx2 v[54:55], v7, s[28:31], 0 offen
L_fin:
L_end:
    s_endpgm
.section .rodata,"a"
.p2align 6
.amdhsa_kernel standalone__modern_conv_block_convnext_v2__vision_kernel
  .amdhsa_next_free_vgpr 168
  .amdhsa_next_free_sgpr 102
  .amdhsa_accum_offset 168
  .amdhsa_group_segment_fixed_size 0
  .amdhsa_kernarg_size 72
  .amdhsa_user_sgpr_count 2
  .amdhsa_user_sgpr_kernarg_segment_ptr 1
  .amdhsa_system_sgpr_workgroup_id_x 1
.end_amdhsa_kernel
```
